```python
import torch

def _softmax(x, axis=-1):
    return torch.softmax(x, dim=axis)
def _gelu(x):
    return torch.nn.functional.gelu(x, approximate="tanh")
def _silu(x):
    return torch.nn.functional.silu(x)
def _sigmoid(x):
    return torch.sigmoid(x)
def _layernorm(x, axis=-1, eps=1e-5):
    m = x.mean(dim=axis, keepdim=True)
    v = x.var(dim=axis, keepdim=True, unbiased=False)
    return (x - m) / torch.sqrt(v + eps)
def _scatter_add(tgt, idx, src, axis=0):
    return tgt.clone().index_add_(axis, idx, src)
def _segment_sum(src, seg, n):
    out = torch.zeros((n,) + src.shape[1:], dtype=src.dtype)
    return out.index_add_(0, seg, src)
def _pad(x, pw):
    flat = tuple(v for pair in reversed(pw) for v in pair)
    return torch.nn.functional.pad(x, flat)

kernel_name = 'parallel_sum__mha_block__dense_activation_relu__prompt'

def setup_inputs():

    _w = (lambda a: (lambda t: t.to(torch.bfloat16) if t.is_floating_point() else t)(torch.as_tensor(a)))
    def _A_setup():
        B, S, D, H = 1, 2048, 1024, 32
        return {
            "x": _w((lambda *s: torch.randn(*s, dtype=torch.bfloat16) * 0.05)(B, S, D)),
            "wqkv": _w((lambda *s: torch.randn(*s, dtype=torch.bfloat16) * 0.05)(D, 3 * D)),
            "wo": _w((lambda *s: torch.randn(*s, dtype=torch.bfloat16) * 0.05)(D, D)),
        }
    _A_in = _A_setup()

    def _B_setup():
        B, S, D, Dff = 1, 2048, 1024, 3584
        return {
            "x": _w((lambda *s: torch.randn(*s, dtype=torch.bfloat16) * 0.05)(B, S, D)),
            "w1": _w((lambda *s: torch.randn(*s, dtype=torch.bfloat16) * 0.05)(D, Dff)),
            "w2": _w((lambda *s: torch.randn(*s, dtype=torch.bfloat16) * 0.05)(Dff, D)),
        }
    _B_in = _B_setup()

    return {
        "A_x": _A_in["x"],
        "A_wqkv": _A_in["wqkv"],
        "A_wo": _A_in["wo"],
        "B_x": _B_in["x"],
        "B_w1": _B_in["w1"],
        "B_w2": _B_in["w2"],
    }

def reference(A_x, A_wqkv, A_wo, B_x, B_w1, B_w2):
    def _A_ref(x, wqkv, wo):
        B, S, D = x.shape
        H = 32
        Dh = D // H
        qkv = (lambda x, *d: x.permute(*d))((x @ wqkv).reshape(B, S, 3, H, Dh), 2, 0, 3, 1, 4)
        q, k, v = qkv[0], qkv[1], qkv[2]
        scores = torch.einsum("bhqd,bhkd->bhqk", q, k) * (Dh ** -0.5)
        p = _softmax(scores, axis=-1)
        o = torch.einsum("bhqk,bhkd->bhqd", p, v)
        return (lambda x, *d: x.permute(*d))(o, 0, 2, 1, 3).reshape(B, S, D) @ wo

    def _B_ref(x, w1, w2):
        h = torch.einsum("bsd,df->bsf", x, w1)
        zero = torch.zeros_like(h)
        h = torch.maximum(h, zero)
        return torch.einsum("bsf,fd->bsd", h, w2)

    x = A_x
    xn = _layernorm(x, axis=-1)
    return x + _A_ref(xn, A_wqkv, A_wo) + _B_ref(xn, B_w1, B_w2)
```

```asm
; @launch kernel=ln_kernel grid=(512,1,1) block=(256,1,1) lds=0
; @launch kernel=gemm1_kernel grid=(208,1,1) block=(512,1,1) lds=131072
; @launch kernel=attn_kernel grid=(768,1,1) block=(256,1,1) lds=49152
; @launch kernel=gemm4_kernel grid=(256,1,1) block=(256,1,1) lds=73728
.amdgcn_target "amdgcn-amd-amdhsa--gfx950"
.text
.globl ln_kernel
.p2align 8
.type ln_kernel,@function
ln_kernel:
    s_cmp_ge_u32 s2, 512
    s_cbranch_scc1 ln_done
    s_load_dwordx16 s[48:63], s[0:1], 0
    s_load_dwordx2 s[64:65], s[0:1], 64
    v_lshrrev_b32 v1, 6, v0
    v_and_b32 v2, 63, v0
    s_lshl_b32 s3, s2, 2
    v_add_u32 v1, s3, v1
    v_lshlrev_b32 v1, 11, v1
    v_lshl_add_u32 v1, v2, 4, v1
    s_waitcnt lgkmcnt(0)
    s_mov_b32 s4, s48
    s_mov_b32 s5, s49
    s_mov_b32 s6, 4194304
    s_mov_b32 s7, 0x00020000
    s_mov_b32 s8, s64
    s_mov_b32 s9, s65
    s_mov_b32 s10, 4194304
    s_mov_b32 s11, 0x00020000
    buffer_load_dwordx4 v[4:7], v1, s[4:7], 0 offen
    buffer_load_dwordx4 v[8:11], v1, s[4:7], 0 offen offset:1024
    s_waitcnt vmcnt(0)
    v_lshlrev_b32 v16, 16, v4
    v_and_b32 v17, 0xffff0000, v4
    v_lshlrev_b32 v18, 16, v5
    v_and_b32 v19, 0xffff0000, v5
    v_lshlrev_b32 v20, 16, v6
    v_and_b32 v21, 0xffff0000, v6
    v_lshlrev_b32 v22, 16, v7
    v_and_b32 v23, 0xffff0000, v7
    v_lshlrev_b32 v24, 16, v8
    v_and_b32 v25, 0xffff0000, v8
    v_lshlrev_b32 v26, 16, v9
    v_and_b32 v27, 0xffff0000, v9
    v_lshlrev_b32 v28, 16, v10
    v_and_b32 v29, 0xffff0000, v10
    v_lshlrev_b32 v30, 16, v11
    v_and_b32 v31, 0xffff0000, v11
    v_add_f32 v12, v16, v17
    v_add_f32 v12, v12, v18
    v_add_f32 v12, v12, v19
    v_add_f32 v12, v12, v20
    v_add_f32 v12, v12, v21
    v_add_f32 v12, v12, v22
    v_add_f32 v12, v12, v23
    v_add_f32 v12, v12, v24
    v_add_f32 v12, v12, v25
    v_add_f32 v12, v12, v26
    v_add_f32 v12, v12, v27
    v_add_f32 v12, v12, v28
    v_add_f32 v12, v12, v29
    v_add_f32 v12, v12, v30
    v_add_f32 v12, v12, v31
    ds_swizzle_b32 v13, v12 offset:1055
    s_waitcnt lgkmcnt(0)
    v_add_f32 v12, v12, v13
    ds_swizzle_b32 v13, v12 offset:2079
    s_waitcnt lgkmcnt(0)
    v_add_f32 v12, v12, v13
    ds_swizzle_b32 v13, v12 offset:4127
    s_waitcnt lgkmcnt(0)
    v_add_f32 v12, v12, v13
    ds_swizzle_b32 v13, v12 offset:8223
    s_waitcnt lgkmcnt(0)
    v_add_f32 v12, v12, v13
    ds_swizzle_b32 v13, v12 offset:16415
    s_waitcnt lgkmcnt(0)
    v_add_f32 v12, v12, v13
    v_mov_b32 v13, v12
    s_nop 1
    v_permlane32_swap_b32 v12, v13
    s_nop 1
    v_add_f32 v12, v12, v13
    v_mul_f32 v12, 981467136, v12
    v_sub_f32 v13, v16, v12
    v_mul_f32 v14, v13, v13
    v_sub_f32 v13, v17, v12
    v_fmac_f32 v14, v13, v13
    v_sub_f32 v13, v18, v12
    v_fmac_f32 v14, v13, v13
    v_sub_f32 v13, v19, v12
    v_fmac_f32 v14, v13, v13
    v_sub_f32 v13, v20, v12
    v_fmac_f32 v14, v13, v13
    v_sub_f32 v13, v21, v12
    v_fmac_f32 v14, v13, v13
    v_sub_f32 v13, v22, v12
    v_fmac_f32 v14, v13, v13
    v_sub_f32 v13, v23, v12
    v_fmac_f32 v14, v13, v13
    v_sub_f32 v13, v24, v12
    v_fmac_f32 v14, v13, v13
    v_sub_f32 v13, v25, v12
    v_fmac_f32 v14, v13, v13
    v_sub_f32 v13, v26, v12
    v_fmac_f32 v14, v13, v13
    v_sub_f32 v13, v27, v12
    v_fmac_f32 v14, v13, v13
    v_sub_f32 v13, v28, v12
    v_fmac_f32 v14, v13, v13
    v_sub_f32 v13, v29, v12
    v_fmac_f32 v14, v13, v13
    v_sub_f32 v13, v30, v12
    v_fmac_f32 v14, v13, v13
    v_sub_f32 v13, v31, v12
    v_fmac_f32 v14, v13, v13
    ds_swizzle_b32 v13, v14 offset:1055
    s_waitcnt lgkmcnt(0)
    v_add_f32 v14, v14, v13
    ds_swizzle_b32 v13, v14 offset:2079
    s_waitcnt lgkmcnt(0)
    v_add_f32 v14, v14, v13
    ds_swizzle_b32 v13, v14 offset:4127
    s_waitcnt lgkmcnt(0)
    v_add_f32 v14, v14, v13
    ds_swizzle_b32 v13, v14 offset:8223
    s_waitcnt lgkmcnt(0)
    v_add_f32 v14, v14, v13
    ds_swizzle_b32 v13, v14 offset:16415
    s_waitcnt lgkmcnt(0)
    v_add_f32 v14, v14, v13
    v_mov_b32 v13, v14
    s_nop 1
    v_permlane32_swap_b32 v14, v13
    s_nop 1
    v_add_f32 v14, v14, v13
    v_mul_f32 v14, 981467136, v14
    v_cvt_pk_bf16_f32 v12, v12, v14
    v_and_b32 v14, 0xffff0000, v12
    v_lshlrev_b32 v12, 16, v12
    v_add_f32 v14, 925353388, v14
    v_cvt_pk_bf16_f32 v14, v14, v14
    v_lshlrev_b32 v14, 16, v14
    v_sqrt_f32 v14, v14
    s_nop 0
    v_cvt_pk_bf16_f32 v14, v14, v14
    v_lshlrev_b32 v14, 16, v14
    v_rcp_f32 v14, v14
    s_nop 0
    v_sub_f32 v16, v16, v12
    v_sub_f32 v17, v17, v12
    v_cvt_pk_bf16_f32 v13, v16, v17
    v_lshlrev_b32 v16, 16, v13
    v_and_b32 v17, 0xffff0000, v13
    v_mul_f32 v16, v16, v14
    v_mul_f32 v17, v17, v14
    v_cvt_pk_bf16_f32 v4, v16, v17
    v_sub_f32 v18, v18, v12
    v_sub_f32 v19, v19, v12
    v_cvt_pk_bf16_f32 v13, v18, v19
    v_lshlrev_b32 v18, 16, v13
    v_and_b32 v19, 0xffff0000, v13
    v_mul_f32 v18, v18, v14
    v_mul_f32 v19, v19, v14
    v_cvt_pk_bf16_f32 v5, v18, v19
    v_sub_f32 v20, v20, v12
    v_sub_f32 v21, v21, v12
    v_cvt_pk_bf16_f32 v13, v20, v21
    v_lshlrev_b32 v20, 16, v13
    v_and_b32 v21, 0xffff0000, v13
    v_mul_f32 v20, v20, v14
    v_mul_f32 v21, v21, v14
    v_cvt_pk_bf16_f32 v6, v20, v21
    v_sub_f32 v22, v22, v12
    v_sub_f32 v23, v23, v12
    v_cvt_pk_bf16_f32 v13, v22, v23
    v_lshlrev_b32 v22, 16, v13
    v_and_b32 v23, 0xffff0000, v13
    v_mul_f32 v22, v22, v14
    v_mul_f32 v23, v23, v14
    v_cvt_pk_bf16_f32 v7, v22, v23
    v_sub_f32 v24, v24, v12
    v_sub_f32 v25, v25, v12
    v_cvt_pk_bf16_f32 v13, v24, v25
    v_lshlrev_b32 v24, 16, v13
    v_and_b32 v25, 0xffff0000, v13
    v_mul_f32 v24, v24, v14
    v_mul_f32 v25, v25, v14
    v_cvt_pk_bf16_f32 v8, v24, v25
    v_sub_f32 v26, v26, v12
    v_sub_f32 v27, v27, v12
    v_cvt_pk_bf16_f32 v13, v26, v27
    v_lshlrev_b32 v26, 16, v13
    v_and_b32 v27, 0xffff0000, v13
    v_mul_f32 v26, v26, v14
    v_mul_f32 v27, v27, v14
    v_cvt_pk_bf16_f32 v9, v26, v27
    v_sub_f32 v28, v28, v12
    v_sub_f32 v29, v29, v12
    v_cvt_pk_bf16_f32 v13, v28, v29
    v_lshlrev_b32 v28, 16, v13
    v_and_b32 v29, 0xffff0000, v13
    v_mul_f32 v28, v28, v14
    v_mul_f32 v29, v29, v14
    v_cvt_pk_bf16_f32 v10, v28, v29
    v_sub_f32 v30, v30, v12
    v_sub_f32 v31, v31, v12
    v_cvt_pk_bf16_f32 v13, v30, v31
    v_lshlrev_b32 v30, 16, v13
    v_and_b32 v31, 0xffff0000, v13
    v_mul_f32 v30, v30, v14
    v_mul_f32 v31, v31, v14
    v_cvt_pk_bf16_f32 v11, v30, v31
    buffer_store_dwordx4 v[4:7], v1, s[8:11], 0 offen
    buffer_store_dwordx4 v[8:11], v1, s[8:11], 0 offen offset:1024
ln_done:
    s_endpgm
.globl gemm1_kernel
.p2align 8
.type gemm1_kernel,@function
gemm1_kernel:
    s_cmp_ge_u32 s2, 208
    s_cbranch_scc1 g1_done
    s_load_dwordx16 s[48:63], s[0:1], 0
    s_load_dwordx2 s[64:65], s[0:1], 64
    s_and_b32 s30, s2, 7
    s_lshr_b32 s31, s2, 3
    s_mul_i32 s30, s30, 26
    s_add_u32 s30, s30, s31
    s_lshr_b32 s35, s30, 3
    s_and_b32 s23, s30, 7
    v_lshrrev_b32 v1, 6, v0
    v_and_b32 v0, 63, v0
    s_nop 0
    v_readfirstlane_b32 s20, v1
    s_lshr_b32 s21, s20, 2
    s_and_b32 s22, s20, 3
    s_waitcnt lgkmcnt(0)
    s_mov_b32 s4, s64
    s_mov_b32 s5, s65
    s_mov_b32 s6, 4194304
    s_mov_b32 s7, 0x00020000
    s_mov_b32 s25, 2048
    s_cmp_ge_u32 s35, 12
    s_cbranch_scc1 g1_w1
    s_mov_b32 s8, s50
    s_mov_b32 s9, s51
    s_mov_b32 s10, 6291456
    s_mov_b32 s11, 0x00020000
    s_mov_b32 s26, 6144
    s_mov_b32 s24, s35
    s_add_u32 s12, s64, 4194304
    s_addc_u32 s13, s65, 0
    s_mov_b32 s14, 12582912
    s_mov_b32 s15, 0x00020000
    s_mov_b32 s36, 64
    s_lshl_b32 s37, s35, 3
    s_lshl_b32 s30, s22, 1
    s_add_u32 s37, s37, s30
    s_lshl_b32 s37, s37, 17
    s_mov_b32 s38, 0x20000
    s_mov_b32 s39, 1048744942
    s_cmp_lt_u32 s35, 4
    s_cselect_b32 s39, s39, 1.0
    s_mov_b32 s40, 0xff800000
    s_cmp_ge_u32 s35, 8
    s_cbranch_scc1 g1_v
    s_branch g1_n
g1_w1:
    s_mov_b32 s8, s56
    s_mov_b32 s9, s57
    s_mov_b32 s10, 7340032
    s_mov_b32 s11, 0x00020000
    s_mov_b32 s26, 7168
    s_sub_u32 s24, s35, 12
    s_add_u32 s12, s64, 16777216
    s_addc_u32 s13, s65, 0
    s_mov_b32 s14, 18874368
    s_mov_b32 s15, 0x00020000
    s_mov_b32 s36, 9216
    s_lshl_b32 s37, s24, 9
    s_lshl_b32 s30, s22, 7
    s_add_u32 s37, s37, s30
    s_add_u32 s37, s37, 2048
    s_mov_b32 s38, 64
    s_mov_b32 s39, 1.0
    s_mov_b32 s40, 0
g1_n:
    v_lshrrev_b32 v16, 2, v0
    v_and_b32 v17, 3, v0
    v_lshrrev_b32 v18, 4, v0
    v_mul_lo_u32 v19, v16, s25
    v_xor_b32 v20, v17, v18
    v_lshl_add_u32 v2, v20, 4, v19
    s_lshl_b32 s30, s25, 4
    v_add_u32 v3, s30, v2
    v_lshrrev_b32 v18, 5, v0
    v_bfe_u32 v16, v0, 2, 3
    v_lshlrev_b32 v17, 4, v17
    v_mul_lo_u32 v19, v18, s26
    v_add_u32 v19, v19, v17
    s_mul_i32 s30, s26, 2
    v_or_b32 v20, 0, v18
    v_xor_b32 v20, v20, v16
    v_lshl_add_u32 v6, v20, 6, v19
    v_or_b32 v20, 2, v18
    v_xor_b32 v20, v20, v16
    v_lshl_add_u32 v7, v20, 6, v19
    v_add_u32 v7, s30, v7
    v_and_b32 v16, 31, v0
    v_lshrrev_b32 v17, 5, v0
    v_bfe_u32 v18, v0, 2, 2
    s_mul_i32 s30, s21, 8192
    v_lshlrev_b32 v19, 6, v16
    v_add_u32 v19, s30, v19
    v_or_b32 v20, 0, v17
    v_xor_b32 v20, v20, v18
    v_lshl_add_u32 v10, v20, 4, v19
    v_or_b32 v20, 2, v17
    v_xor_b32 v20, v20, v18
    v_lshl_add_u32 v11, v20, 4, v19
    v_bfe_u32 v16, v0, 2, 2
    v_lshrrev_b32 v17, 5, v0
    v_lshl_add_u32 v17, v17, 3, v16
    v_lshlrev_b32 v17, 9, v17
    v_bfe_u32 v18, v0, 4, 1
    v_lshl_add_u32 v17, v18, 5, v17
    v_and_b32 v18, 3, v0
    v_lshl_add_u32 v17, v18, 3, v17
    v_add_u32 v17, 16384, v17
    s_lshl_b32 s30, s22, 1
    s_add_u32 s31, s30, 0
    v_xor_b32 v18, s31, v16
    v_lshl_add_u32 v14, v18, 6, v17
    s_add_u32 s31, s30, 1
    v_xor_b32 v18, s31, v16
    v_lshl_add_u32 v15, v18, 6, v17
    s_mul_i32 s30, s23, 256
    s_mul_i32 s31, s20, 32
    s_add_u32 s30, s30, s31
    s_mul_i32 s27, s30, s25
    s_mul_i32 s30, s20, 4
    s_mul_i32 s28, s30, s26
    s_lshl_b32 s30, s24, 9
    s_add_u32 s28, s28, s30
    s_lshl_b32 s33, s26, 5
    s_mul_i32 s32, s20, 2048
    s_mul_i32 s34, s20, 2048
    s_add_u32 s34, s34, 16384
    s_mov_b32 s44, 0
    s_mov_b32 s45, 0x40000000
    v_mov_b32 v80, 0
    v_mov_b32 v81, 0
    v_mov_b32 v82, 0
    v_mov_b32 v83, 0
    v_mov_b32 v84, 0
    v_mov_b32 v85, 0
    v_mov_b32 v86, 0
    v_mov_b32 v87, 0
    v_mov_b32 v88, 0
    v_mov_b32 v89, 0
    v_mov_b32 v90, 0
    v_mov_b32 v91, 0
    v_mov_b32 v92, 0
    v_mov_b32 v93, 0
    v_mov_b32 v94, 0
    v_mov_b32 v95, 0
    v_mov_b32 v96, 0
    v_mov_b32 v97, 0
    v_mov_b32 v98, 0
    v_mov_b32 v99, 0
    v_mov_b32 v100, 0
    v_mov_b32 v101, 0
    v_mov_b32 v102, 0
    v_mov_b32 v103, 0
    v_mov_b32 v104, 0
    v_mov_b32 v105, 0
    v_mov_b32 v106, 0
    v_mov_b32 v107, 0
    v_mov_b32 v108, 0
    v_mov_b32 v109, 0
    v_mov_b32 v110, 0
    v_mov_b32 v111, 0
    v_mov_b32 v112, 0
    v_mov_b32 v113, 0
    v_mov_b32 v114, 0
    v_mov_b32 v115, 0
    v_mov_b32 v116, 0
    v_mov_b32 v117, 0
    v_mov_b32 v118, 0
    v_mov_b32 v119, 0
    v_mov_b32 v120, 0
    v_mov_b32 v121, 0
    v_mov_b32 v122, 0
    v_mov_b32 v123, 0
    v_mov_b32 v124, 0
    v_mov_b32 v125, 0
    v_mov_b32 v126, 0
    v_mov_b32 v127, 0
    v_mov_b32 v128, 0
    v_mov_b32 v129, 0
    v_mov_b32 v130, 0
    v_mov_b32 v131, 0
    v_mov_b32 v132, 0
    v_mov_b32 v133, 0
    v_mov_b32 v134, 0
    v_mov_b32 v135, 0
    v_mov_b32 v136, 0
    v_mov_b32 v137, 0
    v_mov_b32 v138, 0
    v_mov_b32 v139, 0
    v_mov_b32 v140, 0
    v_mov_b32 v141, 0
    v_mov_b32 v142, 0
    v_mov_b32 v143, 0
    v_mov_b32 v144, 0
    v_mov_b32 v145, 0
    v_mov_b32 v146, 0
    v_mov_b32 v147, 0
    v_mov_b32 v148, 0
    v_mov_b32 v149, 0
    v_mov_b32 v150, 0
    v_mov_b32 v151, 0
    v_mov_b32 v152, 0
    v_mov_b32 v153, 0
    v_mov_b32 v154, 0
    v_mov_b32 v155, 0
    v_mov_b32 v156, 0
    v_mov_b32 v157, 0
    v_mov_b32 v158, 0
    v_mov_b32 v159, 0
    v_mov_b32 v160, 0
    v_mov_b32 v161, 0
    v_mov_b32 v162, 0
    v_mov_b32 v163, 0
    v_mov_b32 v164, 0
    v_mov_b32 v165, 0
    v_mov_b32 v166, 0
    v_mov_b32 v167, 0
    v_mov_b32 v168, 0
    v_mov_b32 v169, 0
    v_mov_b32 v170, 0
    v_mov_b32 v171, 0
    v_mov_b32 v172, 0
    v_mov_b32 v173, 0
    v_mov_b32 v174, 0
    v_mov_b32 v175, 0
    v_mov_b32 v176, 0
    v_mov_b32 v177, 0
    v_mov_b32 v178, 0
    v_mov_b32 v179, 0
    v_mov_b32 v180, 0
    v_mov_b32 v181, 0
    v_mov_b32 v182, 0
    v_mov_b32 v183, 0
    v_mov_b32 v184, 0
    v_mov_b32 v185, 0
    v_mov_b32 v186, 0
    v_mov_b32 v187, 0
    v_mov_b32 v188, 0
    v_mov_b32 v189, 0
    v_mov_b32 v190, 0
    v_mov_b32 v191, 0
    v_mov_b32 v192, 0
    v_mov_b32 v193, 0
    v_mov_b32 v194, 0
    v_mov_b32 v195, 0
    v_mov_b32 v196, 0
    v_mov_b32 v197, 0
    v_mov_b32 v198, 0
    v_mov_b32 v199, 0
    v_mov_b32 v200, 0
    v_mov_b32 v201, 0
    v_mov_b32 v202, 0
    v_mov_b32 v203, 0
    v_mov_b32 v204, 0
    v_mov_b32 v205, 0
    v_mov_b32 v206, 0
    v_mov_b32 v207, 0
    s_cmp_lt_u32 s44, 32
    s_cselect_b32 s30, s27, s45
    s_cselect_b32 s31, s28, s45
    s_add_u32 m0, s32, 0
    s_nop 0
    buffer_load_dwordx4 v2, s[4:7], s30 offen lds
    s_add_u32 m0, s32, 1024
    s_nop 0
    buffer_load_dwordx4 v3, s[4:7], s30 offen lds
    s_add_u32 m0, s34, 0
    s_nop 0
    buffer_load_dwordx4 v6, s[8:11], s31 offen lds
    s_add_u32 m0, s34, 1024
    s_nop 0
    buffer_load_dwordx4 v7, s[8:11], s31 offen lds
    s_add_u32 s27, s27, 64
    s_add_u32 s28, s28, s33
    s_add_u32 s44, s44, 1
    s_cmp_lt_u32 s44, 32
    s_cselect_b32 s30, s27, s45
    s_cselect_b32 s31, s28, s45
    s_add_u32 m0, s32, 32768
    s_nop 0
    buffer_load_dwordx4 v2, s[4:7], s30 offen lds
    s_add_u32 m0, s32, 33792
    s_nop 0
    buffer_load_dwordx4 v3, s[4:7], s30 offen lds
    s_add_u32 m0, s34, 32768
    s_nop 0
    buffer_load_dwordx4 v6, s[8:11], s31 offen lds
    s_add_u32 m0, s34, 33792
    s_nop 0
    buffer_load_dwordx4 v7, s[8:11], s31 offen lds
    s_add_u32 s27, s27, 64
    s_add_u32 s28, s28, s33
    s_add_u32 s44, s44, 1
    s_cmp_lt_u32 s44, 32
    s_cselect_b32 s30, s27, s45
    s_cselect_b32 s31, s28, s45
    s_add_u32 m0, s32, 65536
    s_nop 0
    buffer_load_dwordx4 v2, s[4:7], s30 offen lds
    s_add_u32 m0, s32, 66560
    s_nop 0
    buffer_load_dwordx4 v3, s[4:7], s30 offen lds
    s_add_u32 m0, s34, 65536
    s_nop 0
    buffer_load_dwordx4 v6, s[8:11], s31 offen lds
    s_add_u32 m0, s34, 66560
    s_nop 0
    buffer_load_dwordx4 v7, s[8:11], s31 offen lds
    s_add_u32 s27, s27, 64
    s_add_u32 s28, s28, s33
    s_add_u32 s44, s44, 1
    s_cmp_lt_u32 s44, 32
    s_cselect_b32 s30, s27, s45
    s_cselect_b32 s31, s28, s45
    s_add_u32 m0, s32, 98304
    s_nop 0
    buffer_load_dwordx4 v2, s[4:7], s30 offen lds
    s_add_u32 m0, s32, 99328
    s_nop 0
    buffer_load_dwordx4 v3, s[4:7], s30 offen lds
    s_add_u32 m0, s34, 98304
    s_nop 0
    buffer_load_dwordx4 v6, s[8:11], s31 offen lds
    s_add_u32 m0, s34, 99328
    s_nop 0
    buffer_load_dwordx4 v7, s[8:11], s31 offen lds
    s_add_u32 s27, s27, 64
    s_add_u32 s28, s28, s33
    s_add_u32 s44, s44, 1
    s_waitcnt vmcnt(12)
    s_barrier
    ds_read_b128 v[32:35], v10 offset:0
    ds_read_b128 v[36:39], v10 offset:2048
    ds_read_b128 v[40:43], v10 offset:4096
    ds_read_b128 v[44:47], v10 offset:6144
    ds_read_b64_tr_b16 v[48:49], v14 offset:0
    ds_read_b64_tr_b16 v[50:51], v14 offset:2048
    ds_read_b64_tr_b16 v[52:53], v15 offset:0
    ds_read_b64_tr_b16 v[54:55], v15 offset:2048
    s_mov_b32 s29, 32
    s_mov_b32 s66, 0
    s_mov_b32 s67, 32768
    s_mov_b32 s46, 0
g1n_loop:
    v_add_u32 v21, s66, v11
    v_add_u32 v22, s66, v14
    v_add_u32 v23, s66, v15
    s_waitcnt lgkmcnt(0)
    v_mfma_f32_32x32x16_bf16 v[80:95], v[48:51], v[32:35], v[80:95]
    ds_read_b128 v[56:59], v21 offset:0
    ds_read_b128 v[60:63], v21 offset:2048
    v_mfma_f32_32x32x16_bf16 v[96:111], v[52:55], v[32:35], v[96:111]
    ds_read_b128 v[64:67], v21 offset:4096
    ds_read_b128 v[68:71], v21 offset:6144
    v_mfma_f32_32x32x16_bf16 v[112:127], v[48:51], v[36:39], v[112:127]
    ds_read_b64_tr_b16 v[72:73], v22 offset:8192
    ds_read_b64_tr_b16 v[74:75], v22 offset:10240
    v_mfma_f32_32x32x16_bf16 v[128:143], v[52:55], v[36:39], v[128:143]
    ds_read_b64_tr_b16 v[76:77], v23 offset:8192
    ds_read_b64_tr_b16 v[78:79], v23 offset:10240
    v_mfma_f32_32x32x16_bf16 v[144:159], v[48:51], v[40:43], v[144:159]
    v_add_u32 v24, s67, v10
    v_add_u32 v25, s67, v14
    v_add_u32 v26, s67, v15
    v_mfma_f32_32x32x16_bf16 v[160:175], v[52:55], v[40:43], v[160:175]
    v_mfma_f32_32x32x16_bf16 v[176:191], v[48:51], v[44:47], v[176:191]
    v_mfma_f32_32x32x16_bf16 v[192:207], v[52:55], v[44:47], v[192:207]
    s_waitcnt vmcnt(8) lgkmcnt(0)
    s_barrier
    v_mfma_f32_32x32x16_bf16 v[80:95], v[72:75], v[56:59], v[80:95]
    ds_read_b128 v[32:35], v24 offset:0
    ds_read_b128 v[36:39], v24 offset:2048
    s_cmp_lt_u32 s44, 32
    s_cselect_b32 s30, s27, s45
    s_cselect_b32 s31, s28, s45
    s_add_u32 s47, s32, s46
    s_add_u32 m0, s47, 0
    s_nop 0
    buffer_load_dwordx4 v2, s[4:7], s30 offen lds
    v_mfma_f32_32x32x16_bf16 v[96:111], v[76:79], v[56:59], v[96:111]
    ds_read_b128 v[40:43], v24 offset:4096
    ds_read_b128 v[44:47], v24 offset:6144
    s_add_u32 s47, s32, s46
    s_add_u32 m0, s47, 1024
    s_nop 0
    buffer_load_dwordx4 v3, s[4:7], s30 offen lds
    v_mfma_f32_32x32x16_bf16 v[112:127], v[72:75], v[60:63], v[112:127]
    ds_read_b64_tr_b16 v[48:49], v25 offset:0
    ds_read_b64_tr_b16 v[50:51], v25 offset:2048
    s_add_u32 s47, s34, s46
    s_add_u32 m0, s47, 0
    s_nop 0
    buffer_load_dwordx4 v6, s[8:11], s31 offen lds
    v_mfma_f32_32x32x16_bf16 v[128:143], v[76:79], v[60:63], v[128:143]
    ds_read_b64_tr_b16 v[52:53], v26 offset:0
    ds_read_b64_tr_b16 v[54:55], v26 offset:2048
    s_add_u32 s47, s34, s46
    s_add_u32 m0, s47, 1024
    s_nop 0
    buffer_load_dwordx4 v7, s[8:11], s31 offen lds
    s_add_u32 s27, s27, 64
    s_add_u32 s28, s28, s33
    s_add_u32 s44, s44, 1
    v_mfma_f32_32x32x16_bf16 v[144:159], v[72:75], v[64:67], v[144:159]
    v_mfma_f32_32x32x16_bf16 v[160:175], v[76:79], v[64:67], v[160:175]
    v_mfma_f32_32x32x16_bf16 v[176:191], v[72:75], v[68:71], v[176:191]
    v_mfma_f32_32x32x16_bf16 v[192:207], v[76:79], v[68:71], v[192:207]
    s_mov_b32 s46, s67
    s_mov_b32 s66, s67
    s_add_u32 s67, s67, 32768
    s_cmp_eq_u32 s67, 131072
    s_cselect_b32 s67, 0, s67
    s_sub_u32 s29, s29, 1
    s_cmp_lg_u32 s29, 0
    s_cbranch_scc1 g1n_loop
    s_waitcnt vmcnt(0) lgkmcnt(0)
    s_nop 15
    s_nop 3
    s_barrier
    s_mul_i32 s41, s20, 9216
    v_and_b32 v16, 31, v0
    v_mul_u32_u24 v16, 144, v16
    v_lshrrev_b32 v17, 5, v0
    v_lshl_add_u32 v16, v17, 3, v16
    v_add_u32 v16, s41, v16
    v_lshrrev_b32 v17, 3, v0
    v_and_b32 v18, 7, v0
    v_mul_u32_u24 v28, 144, v17
    v_lshl_add_u32 v28, v18, 4, v28
    v_add_u32 v28, s41, v28
    s_lshl_b32 s30, s23, 8
    s_lshl_b32 s31, s21, 7
    s_add_u32 s30, s30, s31
    v_add_u32 v17, s30, v17
    v_mul_lo_u32 v17, v17, s36
    v_bfe_u32 v19, v0, 2, 1
    v_mul_lo_u32 v19, v19, s38
    v_and_b32 v18, 3, v0
    v_lshl_add_u32 v17, v18, 4, v17
    v_add_u32 v17, v17, v19
    s_lshl_b32 s41, s36, 3
    s_mov_b32 s42, s37
    v_mul_f32 v80, s39, v80
    v_max_f32 v80, s40, v80
    v_mul_f32 v81, s39, v81
    v_max_f32 v81, s40, v81
    v_mul_f32 v82, s39, v82
    v_max_f32 v82, s40, v82
    v_mul_f32 v83, s39, v83
    v_max_f32 v83, s40, v83
    v_cvt_pk_bf16_f32 v20, v80, v81
    v_cvt_pk_bf16_f32 v21, v82, v83
    ds_write_b64 v16, v[20:21] offset:0
    v_mul_f32 v84, s39, v84
    v_max_f32 v84, s40, v84
    v_mul_f32 v85, s39, v85
    v_max_f32 v85, s40, v85
    v_mul_f32 v86, s39, v86
    v_max_f32 v86, s40, v86
    v_mul_f32 v87, s39, v87
    v_max_f32 v87, s40, v87
    v_cvt_pk_bf16_f32 v22, v84, v85
    v_cvt_pk_bf16_f32 v23, v86, v87
    ds_write_b64 v16, v[22:23] offset:16
    v_mul_f32 v88, s39, v88
    v_max_f32 v88, s40, v88
    v_mul_f32 v89, s39, v89
    v_max_f32 v89, s40, v89
    v_mul_f32 v90, s39, v90
    v_max_f32 v90, s40, v90
    v_mul_f32 v91, s39, v91
    v_max_f32 v91, s40, v91
    v_cvt_pk_bf16_f32 v24, v88, v89
    v_cvt_pk_bf16_f32 v25, v90, v91
    ds_write_b64 v16, v[24:25] offset:32
    v_mul_f32 v92, s39, v92
    v_max_f32 v92, s40, v92
    v_mul_f32 v93, s39, v93
    v_max_f32 v93, s40, v93
    v_mul_f32 v94, s39, v94
    v_max_f32 v94, s40, v94
    v_mul_f32 v95, s39, v95
    v_max_f32 v95, s40, v95
    v_cvt_pk_bf16_f32 v26, v92, v93
    v_cvt_pk_bf16_f32 v27, v94, v95
    ds_write_b64 v16, v[26:27] offset:48
    v_mul_f32 v96, s39, v96
    v_max_f32 v96, s40, v96
    v_mul_f32 v97, s39, v97
    v_max_f32 v97, s40, v97
    v_mul_f32 v98, s39, v98
    v_max_f32 v98, s40, v98
    v_mul_f32 v99, s39, v99
    v_max_f32 v99, s40, v99
    v_cvt_pk_bf16_f32 v20, v96, v97
    v_cvt_pk_bf16_f32 v21, v98, v99
    ds_write_b64 v16, v[20:21] offset:64
    v_mul_f32 v100, s39, v100
    v_max_f32 v100, s40, v100
    v_mul_f32 v101, s39, v101
    v_max_f32 v101, s40, v101
    v_mul_f32 v102, s39, v102
    v_max_f32 v102, s40, v102
    v_mul_f32 v103, s39, v103
    v_max_f32 v103, s40, v103
    v_cvt_pk_bf16_f32 v22, v100, v101
    v_cvt_pk_bf16_f32 v23, v102, v103
    ds_write_b64 v16, v[22:23] offset:80
    v_mul_f32 v104, s39, v104
    v_max_f32 v104, s40, v104
    v_mul_f32 v105, s39, v105
    v_max_f32 v105, s40, v105
    v_mul_f32 v106, s39, v106
    v_max_f32 v106, s40, v106
    v_mul_f32 v107, s39, v107
    v_max_f32 v107, s40, v107
    v_cvt_pk_bf16_f32 v24, v104, v105
    v_cvt_pk_bf16_f32 v25, v106, v107
    ds_write_b64 v16, v[24:25] offset:96
    v_mul_f32 v108, s39, v108
    v_max_f32 v108, s40, v108
    v_mul_f32 v109, s39, v109
    v_max_f32 v109, s40, v109
    v_mul_f32 v110, s39, v110
    v_max_f32 v110, s40, v110
    v_mul_f32 v111, s39, v111
    v_max_f32 v111, s40, v111
    v_cvt_pk_bf16_f32 v26, v108, v109
    v_cvt_pk_bf16_f32 v27, v110, v111
    ds_write_b64 v16, v[26:27] offset:112
    v_mul_f32 v112, s39, v112
    v_max_f32 v112, s40, v112
    v_mul_f32 v113, s39, v113
    v_max_f32 v113, s40, v113
    v_mul_f32 v114, s39, v114
    v_max_f32 v114, s40, v114
    v_mul_f32 v115, s39, v115
    v_max_f32 v115, s40, v115
    v_cvt_pk_bf16_f32 v20, v112, v113
    v_cvt_pk_bf16_f32 v21, v114, v115
    ds_write_b64 v16, v[20:21] offset:4608
    v_mul_f32 v116, s39, v116
    v_max_f32 v116, s40, v116
    v_mul_f32 v117, s39, v117
    v_max_f32 v117, s40, v117
    v_mul_f32 v118, s39, v118
    v_max_f32 v118, s40, v118
    v_mul_f32 v119, s39, v119
    v_max_f32 v119, s40, v119
    v_cvt_pk_bf16_f32 v22, v116, v117
    v_cvt_pk_bf16_f32 v23, v118, v119
    ds_write_b64 v16, v[22:23] offset:4624
    v_mul_f32 v120, s39, v120
    v_max_f32 v120, s40, v120
    v_mul_f32 v121, s39, v121
    v_max_f32 v121, s40, v121
    v_mul_f32 v122, s39, v122
    v_max_f32 v122, s40, v122
    v_mul_f32 v123, s39, v123
    v_max_f32 v123, s40, v123
    v_cvt_pk_bf16_f32 v24, v120, v121
    v_cvt_pk_bf16_f32 v25, v122, v123
    ds_write_b64 v16, v[24:25] offset:4640
    v_mul_f32 v124, s39, v124
    v_max_f32 v124, s40, v124
    v_mul_f32 v125, s39, v125
    v_max_f32 v125, s40, v125
    v_mul_f32 v126, s39, v126
    v_max_f32 v126, s40, v126
    v_mul_f32 v127, s39, v127
    v_max_f32 v127, s40, v127
    v_cvt_pk_bf16_f32 v26, v124, v125
    v_cvt_pk_bf16_f32 v27, v126, v127
    ds_write_b64 v16, v[26:27] offset:4656
    v_mul_f32 v128, s39, v128
    v_max_f32 v128, s40, v128
    v_mul_f32 v129, s39, v129
    v_max_f32 v129, s40, v129
    v_mul_f32 v130, s39, v130
    v_max_f32 v130, s40, v130
    v_mul_f32 v131, s39, v131
    v_max_f32 v131, s40, v131
    v_cvt_pk_bf16_f32 v20, v128, v129
    v_cvt_pk_bf16_f32 v21, v130, v131
    ds_write_b64 v16, v[20:21] offset:4672
    v_mul_f32 v132, s39, v132
    v_max_f32 v132, s40, v132
    v_mul_f32 v133, s39, v133
    v_max_f32 v133, s40, v133
    v_mul_f32 v134, s39, v134
    v_max_f32 v134, s40, v134
    v_mul_f32 v135, s39, v135
    v_max_f32 v135, s40, v135
    v_cvt_pk_bf16_f32 v22, v132, v133
    v_cvt_pk_bf16_f32 v23, v134, v135
    ds_write_b64 v16, v[22:23] offset:4688
    v_mul_f32 v136, s39, v136
    v_max_f32 v136, s40, v136
    v_mul_f32 v137, s39, v137
    v_max_f32 v137, s40, v137
    v_mul_f32 v138, s39, v138
    v_max_f32 v138, s40, v138
    v_mul_f32 v139, s39, v139
    v_max_f32 v139, s40, v139
    v_cvt_pk_bf16_f32 v24, v136, v137
    v_cvt_pk_bf16_f32 v25, v138, v139
    ds_write_b64 v16, v[24:25] offset:4704
    v_mul_f32 v140, s39, v140
    v_max_f32 v140, s40, v140
    v_mul_f32 v141, s39, v141
    v_max_f32 v141, s40, v141
    v_mul_f32 v142, s39, v142
    v_max_f32 v142, s40, v142
    v_mul_f32 v143, s39, v143
    v_max_f32 v143, s40, v143
    v_cvt_pk_bf16_f32 v26, v140, v141
    v_cvt_pk_bf16_f32 v27, v142, v143
    ds_write_b64 v16, v[26:27] offset:4720
    s_waitcnt lgkmcnt(0)
    ds_read_b128 v[80:83], v28 offset:0
    ds_read_b128 v[84:87], v28 offset:1152
    ds_read_b128 v[88:91], v28 offset:2304
    ds_read_b128 v[92:95], v28 offset:3456
    ds_read_b128 v[96:99], v28 offset:4608
    ds_read_b128 v[100:103], v28 offset:5760
    ds_read_b128 v[104:107], v28 offset:6912
    ds_read_b128 v[108:111], v28 offset:8064
    s_waitcnt lgkmcnt(7)
    buffer_store_dwordx4 v[80:83], v17, s[12:15], s42 offen
    s_add_u32 s42, s42, s41
    s_waitcnt lgkmcnt(6)
    buffer_store_dwordx4 v[84:87], v17, s[12:15], s42 offen
    s_add_u32 s42, s42, s41
    s_waitcnt lgkmcnt(5)
    buffer_store_dwordx4 v[88:91], v17, s[12:15], s42 offen
    s_add_u32 s42, s42, s41
    s_waitcnt lgkmcnt(4)
    buffer_store_dwordx4 v[92:95], v17, s[12:15], s42 offen
    s_add_u32 s42, s42, s41
    s_waitcnt lgkmcnt(3)
    buffer_store_dwordx4 v[96:99], v17, s[12:15], s42 offen
    s_add_u32 s42, s42, s41
    s_waitcnt lgkmcnt(2)
    buffer_store_dwordx4 v[100:103], v17, s[12:15], s42 offen
    s_add_u32 s42, s42, s41
    s_waitcnt lgkmcnt(1)
    buffer_store_dwordx4 v[104:107], v17, s[12:15], s42 offen
    s_add_u32 s42, s42, s41
    s_waitcnt lgkmcnt(0)
    buffer_store_dwordx4 v[108:111], v17, s[12:15], s42 offen
    s_add_u32 s42, s42, s41
    v_mul_f32 v144, s39, v144
    v_max_f32 v144, s40, v144
    v_mul_f32 v145, s39, v145
    v_max_f32 v145, s40, v145
    v_mul_f32 v146, s39, v146
    v_max_f32 v146, s40, v146
    v_mul_f32 v147, s39, v147
    v_max_f32 v147, s40, v147
    v_cvt_pk_bf16_f32 v20, v144, v145
    v_cvt_pk_bf16_f32 v21, v146, v147
    ds_write_b64 v16, v[20:21] offset:0
    v_mul_f32 v148, s39, v148
    v_max_f32 v148, s40, v148
    v_mul_f32 v149, s39, v149
    v_max_f32 v149, s40, v149
    v_mul_f32 v150, s39, v150
    v_max_f32 v150, s40, v150
    v_mul_f32 v151, s39, v151
    v_max_f32 v151, s40, v151
    v_cvt_pk_bf16_f32 v22, v148, v149
    v_cvt_pk_bf16_f32 v23, v150, v151
    ds_write_b64 v16, v[22:23] offset:16
    v_mul_f32 v152, s39, v152
    v_max_f32 v152, s40, v152
    v_mul_f32 v153, s39, v153
    v_max_f32 v153, s40, v153
    v_mul_f32 v154, s39, v154
    v_max_f32 v154, s40, v154
    v_mul_f32 v155, s39, v155
    v_max_f32 v155, s40, v155
    v_cvt_pk_bf16_f32 v24, v152, v153
    v_cvt_pk_bf16_f32 v25, v154, v155
    ds_write_b64 v16, v[24:25] offset:32
    v_mul_f32 v156, s39, v156
    v_max_f32 v156, s40, v156
    v_mul_f32 v157, s39, v157
    v_max_f32 v157, s40, v157
    v_mul_f32 v158, s39, v158
    v_max_f32 v158, s40, v158
    v_mul_f32 v159, s39, v159
    v_max_f32 v159, s40, v159
    v_cvt_pk_bf16_f32 v26, v156, v157
    v_cvt_pk_bf16_f32 v27, v158, v159
    ds_write_b64 v16, v[26:27] offset:48
    v_mul_f32 v160, s39, v160
    v_max_f32 v160, s40, v160
    v_mul_f32 v161, s39, v161
    v_max_f32 v161, s40, v161
    v_mul_f32 v162, s39, v162
    v_max_f32 v162, s40, v162
    v_mul_f32 v163, s39, v163
    v_max_f32 v163, s40, v163
    v_cvt_pk_bf16_f32 v20, v160, v161
    v_cvt_pk_bf16_f32 v21, v162, v163
    ds_write_b64 v16, v[20:21] offset:64
    v_mul_f32 v164, s39, v164
    v_max_f32 v164, s40, v164
    v_mul_f32 v165, s39, v165
    v_max_f32 v165, s40, v165
    v_mul_f32 v166, s39, v166
    v_max_f32 v166, s40, v166
    v_mul_f32 v167, s39, v167
    v_max_f32 v167, s40, v167
    v_cvt_pk_bf16_f32 v22, v164, v165
    v_cvt_pk_bf16_f32 v23, v166, v167
    ds_write_b64 v16, v[22:23] offset:80
    v_mul_f32 v168, s39, v168
    v_max_f32 v168, s40, v168
    v_mul_f32 v169, s39, v169
    v_max_f32 v169, s40, v169
    v_mul_f32 v170, s39, v170
    v_max_f32 v170, s40, v170
    v_mul_f32 v171, s39, v171
    v_max_f32 v171, s40, v171
    v_cvt_pk_bf16_f32 v24, v168, v169
    v_cvt_pk_bf16_f32 v25, v170, v171
    ds_write_b64 v16, v[24:25] offset:96
    v_mul_f32 v172, s39, v172
    v_max_f32 v172, s40, v172
    v_mul_f32 v173, s39, v173
    v_max_f32 v173, s40, v173
    v_mul_f32 v174, s39, v174
    v_max_f32 v174, s40, v174
    v_mul_f32 v175, s39, v175
    v_max_f32 v175, s40, v175
    v_cvt_pk_bf16_f32 v26, v172, v173
    v_cvt_pk_bf16_f32 v27, v174, v175
    ds_write_b64 v16, v[26:27] offset:112
    v_mul_f32 v176, s39, v176
    v_max_f32 v176, s40, v176
    v_mul_f32 v177, s39, v177
    v_max_f32 v177, s40, v177
    v_mul_f32 v178, s39, v178
    v_max_f32 v178, s40, v178
    v_mul_f32 v179, s39, v179
    v_max_f32 v179, s40, v179
    v_cvt_pk_bf16_f32 v20, v176, v177
    v_cvt_pk_bf16_f32 v21, v178, v179
    ds_write_b64 v16, v[20:21] offset:4608
    v_mul_f32 v180, s39, v180
    v_max_f32 v180, s40, v180
    v_mul_f32 v181, s39, v181
    v_max_f32 v181, s40, v181
    v_mul_f32 v182, s39, v182
    v_max_f32 v182, s40, v182
    v_mul_f32 v183, s39, v183
    v_max_f32 v183, s40, v183
    v_cvt_pk_bf16_f32 v22, v180, v181
    v_cvt_pk_bf16_f32 v23, v182, v183
    ds_write_b64 v16, v[22:23] offset:4624
    v_mul_f32 v184, s39, v184
    v_max_f32 v184, s40, v184
    v_mul_f32 v185, s39, v185
    v_max_f32 v185, s40, v185
    v_mul_f32 v186, s39, v186
    v_max_f32 v186, s40, v186
    v_mul_f32 v187, s39, v187
    v_max_f32 v187, s40, v187
    v_cvt_pk_bf16_f32 v24, v184, v185
    v_cvt_pk_bf16_f32 v25, v186, v187
    ds_write_b64 v16, v[24:25] offset:4640
    v_mul_f32 v188, s39, v188
    v_max_f32 v188, s40, v188
    v_mul_f32 v189, s39, v189
    v_max_f32 v189, s40, v189
    v_mul_f32 v190, s39, v190
    v_max_f32 v190, s40, v190
    v_mul_f32 v191, s39, v191
    v_max_f32 v191, s40, v191
    v_cvt_pk_bf16_f32 v26, v188, v189
    v_cvt_pk_bf16_f32 v27, v190, v191
    ds_write_b64 v16, v[26:27] offset:4656
    v_mul_f32 v192, s39, v192
    v_max_f32 v192, s40, v192
    v_mul_f32 v193, s39, v193
    v_max_f32 v193, s40, v193
    v_mul_f32 v194, s39, v194
    v_max_f32 v194, s40, v194
    v_mul_f32 v195, s39, v195
    v_max_f32 v195, s40, v195
    v_cvt_pk_bf16_f32 v20, v192, v193
    v_cvt_pk_bf16_f32 v21, v194, v195
    ds_write_b64 v16, v[20:21] offset:4672
    v_mul_f32 v196, s39, v196
    v_max_f32 v196, s40, v196
    v_mul_f32 v197, s39, v197
    v_max_f32 v197, s40, v197
    v_mul_f32 v198, s39, v198
    v_max_f32 v198, s40, v198
    v_mul_f32 v199, s39, v199
    v_max_f32 v199, s40, v199
    v_cvt_pk_bf16_f32 v22, v196, v197
    v_cvt_pk_bf16_f32 v23, v198, v199
    ds_write_b64 v16, v[22:23] offset:4688
    v_mul_f32 v200, s39, v200
    v_max_f32 v200, s40, v200
    v_mul_f32 v201, s39, v201
    v_max_f32 v201, s40, v201
    v_mul_f32 v202, s39, v202
    v_max_f32 v202, s40, v202
    v_mul_f32 v203, s39, v203
    v_max_f32 v203, s40, v203
    v_cvt_pk_bf16_f32 v24, v200, v201
    v_cvt_pk_bf16_f32 v25, v202, v203
    ds_write_b64 v16, v[24:25] offset:4704
    v_mul_f32 v204, s39, v204
    v_max_f32 v204, s40, v204
    v_mul_f32 v205, s39, v205
    v_max_f32 v205, s40, v205
    v_mul_f32 v206, s39, v206
    v_max_f32 v206, s40, v206
    v_mul_f32 v207, s39, v207
    v_max_f32 v207, s40, v207
    v_cvt_pk_bf16_f32 v26, v204, v205
    v_cvt_pk_bf16_f32 v27, v206, v207
    ds_write_b64 v16, v[26:27] offset:4720
    s_waitcnt lgkmcnt(0)
    ds_read_b128 v[144:147], v28 offset:0
    ds_read_b128 v[148:151], v28 offset:1152
    ds_read_b128 v[152:155], v28 offset:2304
    ds_read_b128 v[156:159], v28 offset:3456
    ds_read_b128 v[160:163], v28 offset:4608
    ds_read_b128 v[164:167], v28 offset:5760
    ds_read_b128 v[168:171], v28 offset:6912
    ds_read_b128 v[172:175], v28 offset:8064
    s_waitcnt lgkmcnt(7)
    buffer_store_dwordx4 v[144:147], v17, s[12:15], s42 offen
    s_add_u32 s42, s42, s41
    s_waitcnt lgkmcnt(6)
    buffer_store_dwordx4 v[148:151], v17, s[12:15], s42 offen
    s_add_u32 s42, s42, s41
    s_waitcnt lgkmcnt(5)
    buffer_store_dwordx4 v[152:155], v17, s[12:15], s42 offen
    s_add_u32 s42, s42, s41
    s_waitcnt lgkmcnt(4)
    buffer_store_dwordx4 v[156:159], v17, s[12:15], s42 offen
    s_add_u32 s42, s42, s41
    s_waitcnt lgkmcnt(3)
    buffer_store_dwordx4 v[160:163], v17, s[12:15], s42 offen
    s_add_u32 s42, s42, s41
    s_waitcnt lgkmcnt(2)
    buffer_store_dwordx4 v[164:167], v17, s[12:15], s42 offen
    s_add_u32 s42, s42, s41
    s_waitcnt lgkmcnt(1)
    buffer_store_dwordx4 v[168:171], v17, s[12:15], s42 offen
    s_add_u32 s42, s42, s41
    s_waitcnt lgkmcnt(0)
    buffer_store_dwordx4 v[172:175], v17, s[12:15], s42 offen
    s_add_u32 s42, s42, s41
    s_endpgm
g1_v:
    v_lshrrev_b32 v16, 2, v0
    v_and_b32 v17, 3, v0
    v_lshrrev_b32 v18, 4, v0
    v_mul_lo_u32 v19, v16, s25
    v_xor_b32 v20, v17, v18
    v_lshl_add_u32 v2, v20, 4, v19
    s_lshl_b32 s30, s25, 4
    v_add_u32 v3, s30, v2
    v_lshrrev_b32 v18, 5, v0
    v_bfe_u32 v16, v0, 2, 3
    v_lshlrev_b32 v17, 4, v17
    v_mul_lo_u32 v19, v18, s26
    v_add_u32 v19, v19, v17
    s_mul_i32 s30, s26, 2
    v_or_b32 v20, 0, v18
    v_xor_b32 v20, v20, v16
    v_lshl_add_u32 v6, v20, 6, v19
    v_or_b32 v20, 2, v18
    v_xor_b32 v20, v20, v16
    v_lshl_add_u32 v7, v20, 6, v19
    v_add_u32 v7, s30, v7
    v_and_b32 v16, 31, v0
    v_lshrrev_b32 v17, 5, v0
    v_bfe_u32 v18, v0, 2, 2
    s_mul_i32 s30, s21, 8192
    v_lshlrev_b32 v19, 6, v16
    v_add_u32 v19, s30, v19
    v_or_b32 v20, 0, v17
    v_xor_b32 v20, v20, v18
    v_lshl_add_u32 v10, v20, 4, v19
    v_or_b32 v20, 2, v17
    v_xor_b32 v20, v20, v18
    v_lshl_add_u32 v11, v20, 4, v19
    v_bfe_u32 v16, v0, 2, 2
    v_lshrrev_b32 v17, 5, v0
    v_lshl_add_u32 v17, v17, 3, v16
    v_lshlrev_b32 v17, 9, v17
    v_bfe_u32 v18, v0, 4, 1
    v_lshl_add_u32 v17, v18, 5, v17
    v_and_b32 v18, 3, v0
    v_lshl_add_u32 v17, v18, 3, v17
    v_add_u32 v17, 16384, v17
    s_lshl_b32 s30, s22, 1
    s_add_u32 s31, s30, 0
    v_xor_b32 v18, s31, v16
    v_lshl_add_u32 v14, v18, 6, v17
    s_add_u32 s31, s30, 1
    v_xor_b32 v18, s31, v16
    v_lshl_add_u32 v15, v18, 6, v17
    s_mul_i32 s30, s23, 256
    s_mul_i32 s31, s20, 32
    s_add_u32 s30, s30, s31
    s_mul_i32 s27, s30, s25
    s_mul_i32 s30, s20, 4
    s_mul_i32 s28, s30, s26
    s_lshl_b32 s30, s24, 9
    s_add_u32 s28, s28, s30
    s_lshl_b32 s33, s26, 5
    s_mul_i32 s32, s20, 2048
    s_mul_i32 s34, s20, 2048
    s_add_u32 s34, s34, 16384
    s_mov_b32 s44, 0
    s_mov_b32 s45, 0x40000000
    v_mov_b32 v80, 0
    v_mov_b32 v81, 0
    v_mov_b32 v82, 0
    v_mov_b32 v83, 0
    v_mov_b32 v84, 0
    v_mov_b32 v85, 0
    v_mov_b32 v86, 0
    v_mov_b32 v87, 0
    v_mov_b32 v88, 0
    v_mov_b32 v89, 0
    v_mov_b32 v90, 0
    v_mov_b32 v91, 0
    v_mov_b32 v92, 0
    v_mov_b32 v93, 0
    v_mov_b32 v94, 0
    v_mov_b32 v95, 0
    v_mov_b32 v96, 0
    v_mov_b32 v97, 0
    v_mov_b32 v98, 0
    v_mov_b32 v99, 0
    v_mov_b32 v100, 0
    v_mov_b32 v101, 0
    v_mov_b32 v102, 0
    v_mov_b32 v103, 0
    v_mov_b32 v104, 0
    v_mov_b32 v105, 0
    v_mov_b32 v106, 0
    v_mov_b32 v107, 0
    v_mov_b32 v108, 0
    v_mov_b32 v109, 0
    v_mov_b32 v110, 0
    v_mov_b32 v111, 0
    v_mov_b32 v112, 0
    v_mov_b32 v113, 0
    v_mov_b32 v114, 0
    v_mov_b32 v115, 0
    v_mov_b32 v116, 0
    v_mov_b32 v117, 0
    v_mov_b32 v118, 0
    v_mov_b32 v119, 0
    v_mov_b32 v120, 0
    v_mov_b32 v121, 0
    v_mov_b32 v122, 0
    v_mov_b32 v123, 0
    v_mov_b32 v124, 0
    v_mov_b32 v125, 0
    v_mov_b32 v126, 0
    v_mov_b32 v127, 0
    v_mov_b32 v128, 0
    v_mov_b32 v129, 0
    v_mov_b32 v130, 0
    v_mov_b32 v131, 0
    v_mov_b32 v132, 0
    v_mov_b32 v133, 0
    v_mov_b32 v134, 0
    v_mov_b32 v135, 0
    v_mov_b32 v136, 0
    v_mov_b32 v137, 0
    v_mov_b32 v138, 0
    v_mov_b32 v139, 0
    v_mov_b32 v140, 0
    v_mov_b32 v141, 0
    v_mov_b32 v142, 0
    v_mov_b32 v143, 0
    v_mov_b32 v144, 0
    v_mov_b32 v145, 0
    v_mov_b32 v146, 0
    v_mov_b32 v147, 0
    v_mov_b32 v148, 0
    v_mov_b32 v149, 0
    v_mov_b32 v150, 0
    v_mov_b32 v151, 0
    v_mov_b32 v152, 0
    v_mov_b32 v153, 0
    v_mov_b32 v154, 0
    v_mov_b32 v155, 0
    v_mov_b32 v156, 0
    v_mov_b32 v157, 0
    v_mov_b32 v158, 0
    v_mov_b32 v159, 0
    v_mov_b32 v160, 0
    v_mov_b32 v161, 0
    v_mov_b32 v162, 0
    v_mov_b32 v163, 0
    v_mov_b32 v164, 0
    v_mov_b32 v165, 0
    v_mov_b32 v166, 0
    v_mov_b32 v167, 0
    v_mov_b32 v168, 0
    v_mov_b32 v169, 0
    v_mov_b32 v170, 0
    v_mov_b32 v171, 0
    v_mov_b32 v172, 0
    v_mov_b32 v173, 0
    v_mov_b32 v174, 0
    v_mov_b32 v175, 0
    v_mov_b32 v176, 0
    v_mov_b32 v177, 0
    v_mov_b32 v178, 0
    v_mov_b32 v179, 0
    v_mov_b32 v180, 0
    v_mov_b32 v181, 0
    v_mov_b32 v182, 0
    v_mov_b32 v183, 0
    v_mov_b32 v184, 0
    v_mov_b32 v185, 0
    v_mov_b32 v186, 0
    v_mov_b32 v187, 0
    v_mov_b32 v188, 0
    v_mov_b32 v189, 0
    v_mov_b32 v190, 0
    v_mov_b32 v191, 0
    v_mov_b32 v192, 0
    v_mov_b32 v193, 0
    v_mov_b32 v194, 0
    v_mov_b32 v195, 0
    v_mov_b32 v196, 0
    v_mov_b32 v197, 0
    v_mov_b32 v198, 0
    v_mov_b32 v199, 0
    v_mov_b32 v200, 0
    v_mov_b32 v201, 0
    v_mov_b32 v202, 0
    v_mov_b32 v203, 0
    v_mov_b32 v204, 0
    v_mov_b32 v205, 0
    v_mov_b32 v206, 0
    v_mov_b32 v207, 0
    s_cmp_lt_u32 s44, 32
    s_cselect_b32 s30, s27, s45
    s_cselect_b32 s31, s28, s45
    s_add_u32 m0, s32, 0
    s_nop 0
    buffer_load_dwordx4 v2, s[4:7], s30 offen lds
    s_add_u32 m0, s32, 1024
    s_nop 0
    buffer_load_dwordx4 v3, s[4:7], s30 offen lds
    s_add_u32 m0, s34, 0
    s_nop 0
    buffer_load_dwordx4 v6, s[8:11], s31 offen lds
    s_add_u32 m0, s34, 1024
    s_nop 0
    buffer_load_dwordx4 v7, s[8:11], s31 offen lds
    s_add_u32 s27, s27, 64
    s_add_u32 s28, s28, s33
    s_add_u32 s44, s44, 1
    s_cmp_lt_u32 s44, 32
    s_cselect_b32 s30, s27, s45
    s_cselect_b32 s31, s28, s45
    s_add_u32 m0, s32, 32768
    s_nop 0
    buffer_load_dwordx4 v2, s[4:7], s30 offen lds
    s_add_u32 m0, s32, 33792
    s_nop 0
    buffer_load_dwordx4 v3, s[4:7], s30 offen lds
    s_add_u32 m0, s34, 32768
    s_nop 0
    buffer_load_dwordx4 v6, s[8:11], s31 offen lds
    s_add_u32 m0, s34, 33792
    s_nop 0
    buffer_load_dwordx4 v7, s[8:11], s31 offen lds
    s_add_u32 s27, s27, 64
    s_add_u32 s28, s28, s33
    s_add_u32 s44, s44, 1
    s_cmp_lt_u32 s44, 32
    s_cselect_b32 s30, s27, s45
    s_cselect_b32 s31, s28, s45
    s_add_u32 m0, s32, 65536
    s_nop 0
    buffer_load_dwordx4 v2, s[4:7], s30 offen lds
    s_add_u32 m0, s32, 66560
    s_nop 0
    buffer_load_dwordx4 v3, s[4:7], s30 offen lds
    s_add_u32 m0, s34, 65536
    s_nop 0
    buffer_load_dwordx4 v6, s[8:11], s31 offen lds
    s_add_u32 m0, s34, 66560
    s_nop 0
    buffer_load_dwordx4 v7, s[8:11], s31 offen lds
    s_add_u32 s27, s27, 64
    s_add_u32 s28, s28, s33
    s_add_u32 s44, s44, 1
    s_cmp_lt_u32 s44, 32
    s_cselect_b32 s30, s27, s45
    s_cselect_b32 s31, s28, s45
    s_add_u32 m0, s32, 98304
    s_nop 0
    buffer_load_dwordx4 v2, s[4:7], s30 offen lds
    s_add_u32 m0, s32, 99328
    s_nop 0
    buffer_load_dwordx4 v3, s[4:7], s30 offen lds
    s_add_u32 m0, s34, 98304
    s_nop 0
    buffer_load_dwordx4 v6, s[8:11], s31 offen lds
    s_add_u32 m0, s34, 99328
    s_nop 0
    buffer_load_dwordx4 v7, s[8:11], s31 offen lds
    s_add_u32 s27, s27, 64
    s_add_u32 s28, s28, s33
    s_add_u32 s44, s44, 1
    s_waitcnt vmcnt(12)
    s_barrier
    ds_read_b128 v[32:35], v10 offset:0
    ds_read_b128 v[36:39], v10 offset:2048
    ds_read_b128 v[40:43], v10 offset:4096
    ds_read_b128 v[44:47], v10 offset:6144
    ds_read_b64_tr_b16 v[48:49], v14 offset:0
    ds_read_b64_tr_b16 v[50:51], v14 offset:2048
    ds_read_b64_tr_b16 v[52:53], v15 offset:0
    ds_read_b64_tr_b16 v[54:55], v15 offset:2048
    s_mov_b32 s29, 32
    s_mov_b32 s66, 0
    s_mov_b32 s67, 32768
    s_mov_b32 s46, 0
g1v_loop:
    v_add_u32 v21, s66, v11
    v_add_u32 v22, s66, v14
    v_add_u32 v23, s66, v15
    s_waitcnt lgkmcnt(0)
    v_mfma_f32_32x32x16_bf16 v[80:95], v[32:35], v[48:51], v[80:95]
    ds_read_b128 v[56:59], v21 offset:0
    ds_read_b128 v[60:63], v21 offset:2048
    v_mfma_f32_32x32x16_bf16 v[96:111], v[32:35], v[52:55], v[96:111]
    ds_read_b128 v[64:67], v21 offset:4096
    ds_read_b128 v[68:71], v21 offset:6144
    v_mfma_f32_32x32x16_bf16 v[112:127], v[36:39], v[48:51], v[112:127]
    ds_read_b64_tr_b16 v[72:73], v22 offset:8192
    ds_read_b64_tr_b16 v[74:75], v22 offset:10240
    v_mfma_f32_32x32x16_bf16 v[128:143], v[36:39], v[52:55], v[128:143]
    ds_read_b64_tr_b16 v[76:77], v23 offset:8192
    ds_read_b64_tr_b16 v[78:79], v23 offset:10240
    v_mfma_f32_32x32x16_bf16 v[144:159], v[40:43], v[48:51], v[144:159]
    v_add_u32 v24, s67, v10
    v_add_u32 v25, s67, v14
    v_add_u32 v26, s67, v15
    v_mfma_f32_32x32x16_bf16 v[160:175], v[40:43], v[52:55], v[160:175]
    v_mfma_f32_32x32x16_bf16 v[176:191], v[44:47], v[48:51], v[176:191]
    v_mfma_f32_32x32x16_bf16 v[192:207], v[44:47], v[52:55], v[192:207]
    s_waitcnt vmcnt(8) lgkmcnt(0)
    s_barrier
    v_mfma_f32_32x32x16_bf16 v[80:95], v[56:59], v[72:75], v[80:95]
    ds_read_b128 v[32:35], v24 offset:0
    ds_read_b128 v[36:39], v24 offset:2048
    s_cmp_lt_u32 s44, 32
    s_cselect_b32 s30, s27, s45
    s_cselect_b32 s31, s28, s45
    s_add_u32 s47, s32, s46
    s_add_u32 m0, s47, 0
    s_nop 0
    buffer_load_dwordx4 v2, s[4:7], s30 offen lds
    v_mfma_f32_32x32x16_bf16 v[96:111], v[56:59], v[76:79], v[96:111]
    ds_read_b128 v[40:43], v24 offset:4096
    ds_read_b128 v[44:47], v24 offset:6144
    s_add_u32 s47, s32, s46
    s_add_u32 m0, s47, 1024
    s_nop 0
    buffer_load_dwordx4 v3, s[4:7], s30 offen lds
    v_mfma_f32_32x32x16_bf16 v[112:127], v[60:63], v[72:75], v[112:127]
    ds_read_b64_tr_b16 v[48:49], v25 offset:0
    ds_read_b64_tr_b16 v[50:51], v25 offset:2048
    s_add_u32 s47, s34, s46
    s_add_u32 m0, s47, 0
    s_nop 0
    buffer_load_dwordx4 v6, s[8:11], s31 offen lds
    v_mfma_f32_32x32x16_bf16 v[128:143], v[60:63], v[76:79], v[128:143]
    ds_read_b64_tr_b16 v[52:53], v26 offset:0
    ds_read_b64_tr_b16 v[54:55], v26 offset:2048
    s_add_u32 s47, s34, s46
    s_add_u32 m0, s47, 1024
    s_nop 0
    buffer_load_dwordx4 v7, s[8:11], s31 offen lds
    s_add_u32 s27, s27, 64
    s_add_u32 s28, s28, s33
    s_add_u32 s44, s44, 1
    v_mfma_f32_32x32x16_bf16 v[144:159], v[64:67], v[72:75], v[144:159]
    v_mfma_f32_32x32x16_bf16 v[160:175], v[64:67], v[76:79], v[160:175]
    v_mfma_f32_32x32x16_bf16 v[176:191], v[68:71], v[72:75], v[176:191]
    v_mfma_f32_32x32x16_bf16 v[192:207], v[68:71], v[76:79], v[192:207]
    s_mov_b32 s46, s67
    s_mov_b32 s66, s67
    s_add_u32 s67, s67, 32768
    s_cmp_eq_u32 s67, 131072
    s_cselect_b32 s67, 0, s67
    s_sub_u32 s29, s29, 1
    s_cmp_lg_u32 s29, 0
    s_cbranch_scc1 g1v_loop
    s_waitcnt vmcnt(0) lgkmcnt(0)
    s_nop 15
    s_nop 3
    s_barrier
    s_mul_i32 s41, s20, 9216
    v_and_b32 v16, 31, v0
    v_mul_u32_u24 v16, 144, v16
    v_lshrrev_b32 v17, 5, v0
    v_lshl_add_u32 v16, v17, 3, v16
    v_add_u32 v16, s41, v16
    v_lshrrev_b32 v17, 3, v0
    v_and_b32 v18, 7, v0
    v_mul_u32_u24 v28, 144, v17
    v_lshl_add_u32 v28, v18, 4, v28
    v_add_u32 v28, s41, v28
    v_lshlrev_b32 v17, 12, v17
    v_lshl_add_u32 v17, v18, 4, v17
    s_lshl_b32 s30, s23, 9
    s_lshl_b32 s31, s21, 8
    s_add_u32 s30, s30, s31
    s_add_u32 s37, s37, s30
    v_cvt_pk_bf16_f32 v20, v80, v81
    v_cvt_pk_bf16_f32 v21, v82, v83
    ds_write_b64 v16, v[20:21] offset:0
    v_cvt_pk_bf16_f32 v22, v84, v85
    v_cvt_pk_bf16_f32 v23, v86, v87
    ds_write_b64 v16, v[22:23] offset:16
    v_cvt_pk_bf16_f32 v24, v88, v89
    v_cvt_pk_bf16_f32 v25, v90, v91
    ds_write_b64 v16, v[24:25] offset:32
    v_cvt_pk_bf16_f32 v26, v92, v93
    v_cvt_pk_bf16_f32 v27, v94, v95
    ds_write_b64 v16, v[26:27] offset:48
    v_cvt_pk_bf16_f32 v20, v96, v97
    v_cvt_pk_bf16_f32 v21, v98, v99
    ds_write_b64 v16, v[20:21] offset:4608
    v_cvt_pk_bf16_f32 v22, v100, v101
    v_cvt_pk_bf16_f32 v23, v102, v103
    ds_write_b64 v16, v[22:23] offset:4624
    v_cvt_pk_bf16_f32 v24, v104, v105
    v_cvt_pk_bf16_f32 v25, v106, v107
    ds_write_b64 v16, v[24:25] offset:4640
    v_cvt_pk_bf16_f32 v26, v108, v109
    v_cvt_pk_bf16_f32 v27, v110, v111
    ds_write_b64 v16, v[26:27] offset:4656
    v_cvt_pk_bf16_f32 v20, v112, v113
    v_cvt_pk_bf16_f32 v21, v114, v115
    ds_write_b64 v16, v[20:21] offset:64
    v_cvt_pk_bf16_f32 v22, v116, v117
    v_cvt_pk_bf16_f32 v23, v118, v119
    ds_write_b64 v16, v[22:23] offset:80
    v_cvt_pk_bf16_f32 v24, v120, v121
    v_cvt_pk_bf16_f32 v25, v122, v123
    ds_write_b64 v16, v[24:25] offset:96
    v_cvt_pk_bf16_f32 v26, v124, v125
    v_cvt_pk_bf16_f32 v27, v126, v127
    ds_write_b64 v16, v[26:27] offset:112
    v_cvt_pk_bf16_f32 v20, v128, v129
    v_cvt_pk_bf16_f32 v21, v130, v131
    ds_write_b64 v16, v[20:21] offset:4672
    v_cvt_pk_bf16_f32 v22, v132, v133
    v_cvt_pk_bf16_f32 v23, v134, v135
    ds_write_b64 v16, v[22:23] offset:4688
    v_cvt_pk_bf16_f32 v24, v136, v137
    v_cvt_pk_bf16_f32 v25, v138, v139
    ds_write_b64 v16, v[24:25] offset:4704
    v_cvt_pk_bf16_f32 v26, v140, v141
    v_cvt_pk_bf16_f32 v27, v142, v143
    ds_write_b64 v16, v[26:27] offset:4720
    s_waitcnt lgkmcnt(0)
    ds_read_b128 v[80:83], v28 offset:0
    ds_read_b128 v[84:87], v28 offset:1152
    ds_read_b128 v[88:91], v28 offset:2304
    ds_read_b128 v[92:95], v28 offset:3456
    ds_read_b128 v[96:99], v28 offset:4608
    ds_read_b128 v[100:103], v28 offset:5760
    ds_read_b128 v[104:107], v28 offset:6912
    ds_read_b128 v[108:111], v28 offset:8064
    s_add_u32 s42, s37, 0
    s_waitcnt lgkmcnt(7)
    buffer_store_dwordx4 v[80:83], v17, s[12:15], s42 offen
    s_add_u32 s42, s37, 32768
    s_waitcnt lgkmcnt(6)
    buffer_store_dwordx4 v[84:87], v17, s[12:15], s42 offen
    s_add_u32 s42, s37, 65536
    s_waitcnt lgkmcnt(5)
    buffer_store_dwordx4 v[88:91], v17, s[12:15], s42 offen
    s_add_u32 s42, s37, 98304
    s_waitcnt lgkmcnt(4)
    buffer_store_dwordx4 v[92:95], v17, s[12:15], s42 offen
    s_add_u32 s42, s37, 131072
    s_waitcnt lgkmcnt(3)
    buffer_store_dwordx4 v[96:99], v17, s[12:15], s42 offen
    s_add_u32 s42, s37, 163840
    s_waitcnt lgkmcnt(2)
    buffer_store_dwordx4 v[100:103], v17, s[12:15], s42 offen
    s_add_u32 s42, s37, 196608
    s_waitcnt lgkmcnt(1)
    buffer_store_dwordx4 v[104:107], v17, s[12:15], s42 offen
    s_add_u32 s42, s37, 229376
    s_waitcnt lgkmcnt(0)
    buffer_store_dwordx4 v[108:111], v17, s[12:15], s42 offen
    v_cvt_pk_bf16_f32 v20, v144, v145
    v_cvt_pk_bf16_f32 v21, v146, v147
    ds_write_b64 v16, v[20:21] offset:0
    v_cvt_pk_bf16_f32 v22, v148, v149
    v_cvt_pk_bf16_f32 v23, v150, v151
    ds_write_b64 v16, v[22:23] offset:16
    v_cvt_pk_bf16_f32 v24, v152, v153
    v_cvt_pk_bf16_f32 v25, v154, v155
    ds_write_b64 v16, v[24:25] offset:32
    v_cvt_pk_bf16_f32 v26, v156, v157
    v_cvt_pk_bf16_f32 v27, v158, v159
    ds_write_b64 v16, v[26:27] offset:48
    v_cvt_pk_bf16_f32 v20, v160, v161
    v_cvt_pk_bf16_f32 v21, v162, v163
    ds_write_b64 v16, v[20:21] offset:4608
    v_cvt_pk_bf16_f32 v22, v164, v165
    v_cvt_pk_bf16_f32 v23, v166, v167
    ds_write_b64 v16, v[22:23] offset:4624
    v_cvt_pk_bf16_f32 v24, v168, v169
    v_cvt_pk_bf16_f32 v25, v170, v171
    ds_write_b64 v16, v[24:25] offset:4640
    v_cvt_pk_bf16_f32 v26, v172, v173
    v_cvt_pk_bf16_f32 v27, v174, v175
    ds_write_b64 v16, v[26:27] offset:4656
    v_cvt_pk_bf16_f32 v20, v176, v177
    v_cvt_pk_bf16_f32 v21, v178, v179
    ds_write_b64 v16, v[20:21] offset:64
    v_cvt_pk_bf16_f32 v22, v180, v181
    v_cvt_pk_bf16_f32 v23, v182, v183
    ds_write_b64 v16, v[22:23] offset:80
    v_cvt_pk_bf16_f32 v24, v184, v185
    v_cvt_pk_bf16_f32 v25, v186, v187
    ds_write_b64 v16, v[24:25] offset:96
    v_cvt_pk_bf16_f32 v26, v188, v189
    v_cvt_pk_bf16_f32 v27, v190, v191
    ds_write_b64 v16, v[26:27] offset:112
    v_cvt_pk_bf16_f32 v20, v192, v193
    v_cvt_pk_bf16_f32 v21, v194, v195
    ds_write_b64 v16, v[20:21] offset:4672
    v_cvt_pk_bf16_f32 v22, v196, v197
    v_cvt_pk_bf16_f32 v23, v198, v199
    ds_write_b64 v16, v[22:23] offset:4688
    v_cvt_pk_bf16_f32 v24, v200, v201
    v_cvt_pk_bf16_f32 v25, v202, v203
    ds_write_b64 v16, v[24:25] offset:4704
    v_cvt_pk_bf16_f32 v26, v204, v205
    v_cvt_pk_bf16_f32 v27, v206, v207
    ds_write_b64 v16, v[26:27] offset:4720
    s_waitcnt lgkmcnt(0)
    ds_read_b128 v[144:147], v28 offset:0
    ds_read_b128 v[148:151], v28 offset:1152
    ds_read_b128 v[152:155], v28 offset:2304
    ds_read_b128 v[156:159], v28 offset:3456
    ds_read_b128 v[160:163], v28 offset:4608
    ds_read_b128 v[164:167], v28 offset:5760
    ds_read_b128 v[168:171], v28 offset:6912
    ds_read_b128 v[172:175], v28 offset:8064
    s_add_u32 s42, s37, 128
    s_waitcnt lgkmcnt(7)
    buffer_store_dwordx4 v[144:147], v17, s[12:15], s42 offen
    s_add_u32 s42, s37, 32896
    s_waitcnt lgkmcnt(6)
    buffer_store_dwordx4 v[148:151], v17, s[12:15], s42 offen
    s_add_u32 s42, s37, 65664
    s_waitcnt lgkmcnt(5)
    buffer_store_dwordx4 v[152:155], v17, s[12:15], s42 offen
    s_add_u32 s42, s37, 98432
    s_waitcnt lgkmcnt(4)
    buffer_store_dwordx4 v[156:159], v17, s[12:15], s42 offen
    s_add_u32 s42, s37, 131200
    s_waitcnt lgkmcnt(3)
    buffer_store_dwordx4 v[160:163], v17, s[12:15], s42 offen
    s_add_u32 s42, s37, 163968
    s_waitcnt lgkmcnt(2)
    buffer_store_dwordx4 v[164:167], v17, s[12:15], s42 offen
    s_add_u32 s42, s37, 196736
    s_waitcnt lgkmcnt(1)
    buffer_store_dwordx4 v[168:171], v17, s[12:15], s42 offen
    s_add_u32 s42, s37, 229504
    s_waitcnt lgkmcnt(0)
    buffer_store_dwordx4 v[172:175], v17, s[12:15], s42 offen
g1_done:
    s_endpgm
.globl attn_kernel
.p2align 8
.type attn_kernel,@function
attn_kernel:
    s_cmp_ge_u32 s2, 768
    s_cbranch_scc1 at_done
    s_load_dwordx16 s[48:63], s[0:1], 0
    s_load_dwordx2 s[64:65], s[0:1], 64
    s_cmp_ge_u32 s2, 256
    s_cbranch_scc1 at_go
    s_and_b32 s30, s2, 7
    s_lshr_b32 s31, s2, 3
    s_lshl_b32 s30, s30, 5
    s_add_u32 s30, s30, s31
    s_lshr_b32 s23, s30, 4
    s_and_b32 s24, s30, 7
    s_bfe_u32 s35, s30, 0x10003
    v_lshrrev_b32 v1, 6, v0
    v_and_b32 v0, 63, v0
    s_nop 0
    v_readfirstlane_b32 s20, v1
    s_lshr_b32 s21, s20, 1
    s_and_b32 s22, s20, 1
    s_waitcnt lgkmcnt(0)
    s_add_u32 s4, s64, 16779264
    s_addc_u32 s5, s65, 0
    s_mov_b32 s6, 18872320
    s_mov_b32 s7, 0x00020000
    s_mov_b32 s8, s58
    s_mov_b32 s9, s59
    s_mov_b32 s10, 7340032
    s_mov_b32 s11, 0x00020000
    s_add_u32 s12, s64, 41943040
    s_addc_u32 s13, s65, 0
    s_mov_b32 s14, 16777216
    s_mov_b32 s15, 0x00020000
    s_mul_i32 s30, s35, 3584
    s_add_u32 s4, s4, s30
    s_addc_u32 s5, s5, 0
    s_sub_u32 s6, s6, s30
    s_mul_i32 s30, s35, 3670016
    s_add_u32 s8, s8, s30
    s_addc_u32 s9, s9, 0
    s_sub_u32 s10, s10, s30
    s_mov_b32 s25, 9216
    s_mov_b32 s26, 2048
    v_lshrrev_b32 v16, 2, v0
    v_and_b32 v17, 3, v0
    v_lshrrev_b32 v18, 4, v0
    v_mul_lo_u32 v19, v16, s25
    v_xor_b32 v20, v17, v18
    v_lshl_add_u32 v2, v20, 4, v19
    s_lshl_b32 s30, s25, 4
    v_add_u32 v3, s30, v2
    v_lshrrev_b32 v18, 4, v0
    v_bfe_u32 v16, v0, 2, 2
    v_lshlrev_b32 v17, 4, v17
    v_mul_lo_u32 v19, v18, s26
    v_add_u32 v19, v19, v17
    s_mul_i32 s30, s26, 4
    v_or_b32 v20, 0, v18
    v_xor_b32 v20, v20, v16
    v_lshl_add_u32 v6, v20, 6, v19
    v_or_b32 v20, 0, v18
    v_xor_b32 v20, v20, v16
    v_lshl_add_u32 v7, v20, 6, v19
    v_add_u32 v7, s30, v7
    v_and_b32 v16, 31, v0
    v_lshrrev_b32 v17, 5, v0
    v_bfe_u32 v18, v0, 2, 2
    s_mul_i32 s30, s21, 4096
    v_lshlrev_b32 v19, 6, v16
    v_add_u32 v19, s30, v19
    v_or_b32 v20, 0, v17
    v_xor_b32 v20, v20, v18
    v_lshl_add_u32 v10, v20, 4, v19
    v_or_b32 v20, 2, v17
    v_xor_b32 v20, v20, v18
    v_lshl_add_u32 v11, v20, 4, v19
    v_bfe_u32 v16, v0, 2, 2
    v_lshrrev_b32 v17, 5, v0
    v_lshl_add_u32 v17, v17, 3, v16
    v_lshlrev_b32 v17, 8, v17
    v_bfe_u32 v18, v0, 4, 1
    v_lshl_add_u32 v17, v18, 5, v17
    v_and_b32 v18, 3, v0
    v_lshl_add_u32 v17, v18, 3, v17
    v_add_u32 v17, 8192, v17
    s_lshl_b32 s30, s22, 1
    s_add_u32 s31, s30, 0
    v_xor_b32 v18, s31, v16
    v_lshl_add_u32 v14, v18, 6, v17
    s_add_u32 s31, s30, 1
    v_xor_b32 v18, s31, v16
    v_lshl_add_u32 v15, v18, 6, v17
    s_mul_i32 s30, s23, 128
    s_mul_i32 s31, s20, 32
    s_add_u32 s30, s30, s31
    s_mul_i32 s27, s30, s25
    s_mul_i32 s30, s20, 8
    s_mul_i32 s28, s30, s26
    s_lshl_b32 s30, s24, 8
    s_add_u32 s28, s28, s30
    s_lshl_b32 s33, s26, 5
    s_mul_i32 s32, s20, 2048
    s_mul_i32 s34, s20, 2048
    s_add_u32 s34, s34, 8192
    s_mov_b32 s44, 0
    s_mov_b32 s45, 0x40000000
    v_mov_b32 v64, 0
    v_mov_b32 v65, 0
    v_mov_b32 v66, 0
    v_mov_b32 v67, 0
    v_mov_b32 v68, 0
    v_mov_b32 v69, 0
    v_mov_b32 v70, 0
    v_mov_b32 v71, 0
    v_mov_b32 v72, 0
    v_mov_b32 v73, 0
    v_mov_b32 v74, 0
    v_mov_b32 v75, 0
    v_mov_b32 v76, 0
    v_mov_b32 v77, 0
    v_mov_b32 v78, 0
    v_mov_b32 v79, 0
    v_mov_b32 v80, 0
    v_mov_b32 v81, 0
    v_mov_b32 v82, 0
    v_mov_b32 v83, 0
    v_mov_b32 v84, 0
    v_mov_b32 v85, 0
    v_mov_b32 v86, 0
    v_mov_b32 v87, 0
    v_mov_b32 v88, 0
    v_mov_b32 v89, 0
    v_mov_b32 v90, 0
    v_mov_b32 v91, 0
    v_mov_b32 v92, 0
    v_mov_b32 v93, 0
    v_mov_b32 v94, 0
    v_mov_b32 v95, 0
    v_mov_b32 v96, 0
    v_mov_b32 v97, 0
    v_mov_b32 v98, 0
    v_mov_b32 v99, 0
    v_mov_b32 v100, 0
    v_mov_b32 v101, 0
    v_mov_b32 v102, 0
    v_mov_b32 v103, 0
    v_mov_b32 v104, 0
    v_mov_b32 v105, 0
    v_mov_b32 v106, 0
    v_mov_b32 v107, 0
    v_mov_b32 v108, 0
    v_mov_b32 v109, 0
    v_mov_b32 v110, 0
    v_mov_b32 v111, 0
    v_mov_b32 v112, 0
    v_mov_b32 v113, 0
    v_mov_b32 v114, 0
    v_mov_b32 v115, 0
    v_mov_b32 v116, 0
    v_mov_b32 v117, 0
    v_mov_b32 v118, 0
    v_mov_b32 v119, 0
    v_mov_b32 v120, 0
    v_mov_b32 v121, 0
    v_mov_b32 v122, 0
    v_mov_b32 v123, 0
    v_mov_b32 v124, 0
    v_mov_b32 v125, 0
    v_mov_b32 v126, 0
    v_mov_b32 v127, 0
    s_cmp_lt_u32 s44, 56
    s_cselect_b32 s30, s27, s45
    s_cselect_b32 s31, s28, s45
    s_add_u32 m0, s32, 0
    s_nop 0
    buffer_load_dwordx4 v2, s[4:7], s30 offen lds
    s_add_u32 m0, s32, 1024
    s_nop 0
    buffer_load_dwordx4 v3, s[4:7], s30 offen lds
    s_add_u32 m0, s34, 0
    s_nop 0
    buffer_load_dwordx4 v6, s[8:11], s31 offen lds
    s_add_u32 m0, s34, 1024
    s_nop 0
    buffer_load_dwordx4 v7, s[8:11], s31 offen lds
    s_add_u32 s27, s27, 64
    s_add_u32 s28, s28, s33
    s_add_u32 s44, s44, 1
    s_cmp_lt_u32 s44, 56
    s_cselect_b32 s30, s27, s45
    s_cselect_b32 s31, s28, s45
    s_add_u32 m0, s32, 16384
    s_nop 0
    buffer_load_dwordx4 v2, s[4:7], s30 offen lds
    s_add_u32 m0, s32, 17408
    s_nop 0
    buffer_load_dwordx4 v3, s[4:7], s30 offen lds
    s_add_u32 m0, s34, 16384
    s_nop 0
    buffer_load_dwordx4 v6, s[8:11], s31 offen lds
    s_add_u32 m0, s34, 17408
    s_nop 0
    buffer_load_dwordx4 v7, s[8:11], s31 offen lds
    s_add_u32 s27, s27, 64
    s_add_u32 s28, s28, s33
    s_add_u32 s44, s44, 1
    s_cmp_lt_u32 s44, 56
    s_cselect_b32 s30, s27, s45
    s_cselect_b32 s31, s28, s45
    s_add_u32 m0, s32, 32768
    s_nop 0
    buffer_load_dwordx4 v2, s[4:7], s30 offen lds
    s_add_u32 m0, s32, 33792
    s_nop 0
    buffer_load_dwordx4 v3, s[4:7], s30 offen lds
    s_add_u32 m0, s34, 32768
    s_nop 0
    buffer_load_dwordx4 v6, s[8:11], s31 offen lds
    s_add_u32 m0, s34, 33792
    s_nop 0
    buffer_load_dwordx4 v7, s[8:11], s31 offen lds
    s_add_u32 s27, s27, 64
    s_add_u32 s28, s28, s33
    s_add_u32 s44, s44, 1
    s_waitcnt vmcnt(8)
    s_barrier
    ds_read_b128 v[32:35], v10 offset:0
    ds_read_b128 v[36:39], v10 offset:2048
    ds_read_b64_tr_b16 v[40:41], v14 offset:0
    ds_read_b64_tr_b16 v[42:43], v14 offset:1024
    ds_read_b64_tr_b16 v[44:45], v15 offset:0
    ds_read_b64_tr_b16 v[46:47], v15 offset:1024
    s_mov_b32 s29, 56
    s_mov_b32 s66, 0
    s_mov_b32 s67, 16384
    s_mov_b32 s46, 0
f2_loop:
    v_add_u32 v21, s66, v11
    v_add_u32 v22, s66, v14
    v_add_u32 v23, s66, v15
    s_waitcnt lgkmcnt(0)
    v_mfma_f32_32x32x16_bf16 v[64:79], v[40:43], v[32:35], v[64:79]
    ds_read_b128 v[48:51], v21 offset:0
    ds_read_b128 v[52:55], v21 offset:2048
    v_mfma_f32_32x32x16_bf16 v[80:95], v[44:47], v[32:35], v[80:95]
    ds_read_b64_tr_b16 v[56:57], v22 offset:4096
    ds_read_b64_tr_b16 v[58:59], v22 offset:5120
    v_mfma_f32_32x32x16_bf16 v[96:111], v[40:43], v[36:39], v[96:111]
    ds_read_b64_tr_b16 v[60:61], v23 offset:4096
    ds_read_b64_tr_b16 v[62:63], v23 offset:5120
    v_mfma_f32_32x32x16_bf16 v[112:127], v[44:47], v[36:39], v[112:127]
    v_add_u32 v24, s67, v10
    v_add_u32 v25, s67, v14
    v_add_u32 v26, s67, v15
    s_waitcnt vmcnt(4) lgkmcnt(0)
    s_barrier
    v_mfma_f32_32x32x16_bf16 v[64:79], v[56:59], v[48:51], v[64:79]
    ds_read_b128 v[32:35], v24 offset:0
    ds_read_b128 v[36:39], v24 offset:2048
    s_cmp_lt_u32 s44, 56
    s_cselect_b32 s30, s27, s45
    s_cselect_b32 s31, s28, s45
    s_add_u32 s47, s32, s46
    s_add_u32 m0, s47, 0
    s_nop 0
    buffer_load_dwordx4 v2, s[4:7], s30 offen lds
    v_mfma_f32_32x32x16_bf16 v[80:95], v[60:63], v[48:51], v[80:95]
    ds_read_b64_tr_b16 v[40:41], v25 offset:0
    ds_read_b64_tr_b16 v[42:43], v25 offset:1024
    s_add_u32 s47, s32, s46
    s_add_u32 m0, s47, 1024
    s_nop 0
    buffer_load_dwordx4 v3, s[4:7], s30 offen lds
    v_mfma_f32_32x32x16_bf16 v[96:111], v[56:59], v[52:55], v[96:111]
    ds_read_b64_tr_b16 v[44:45], v26 offset:0
    ds_read_b64_tr_b16 v[46:47], v26 offset:1024
    s_add_u32 s47, s34, s46
    s_add_u32 m0, s47, 0
    s_nop 0
    buffer_load_dwordx4 v6, s[8:11], s31 offen lds
    v_mfma_f32_32x32x16_bf16 v[112:127], v[60:63], v[52:55], v[112:127]
    s_add_u32 s47, s34, s46
    s_add_u32 m0, s47, 1024
    s_nop 0
    buffer_load_dwordx4 v7, s[8:11], s31 offen lds
    s_add_u32 s27, s27, 64
    s_add_u32 s28, s28, s33
    s_add_u32 s44, s44, 1
    s_mov_b32 s46, s67
    s_mov_b32 s66, s67
    s_add_u32 s67, s67, 16384
    s_cmp_eq_u32 s67, 49152
    s_cselect_b32 s67, 0, s67
    s_sub_u32 s29, s29, 1
    s_cmp_lg_u32 s29, 0
    s_cbranch_scc1 f2_loop
    s_waitcnt vmcnt(0) lgkmcnt(0)
    s_nop 15
    s_nop 3
    v_lshlrev_b32 v16, 4, v0
    s_lshl_b32 s30, s23, 2
    s_lshl_b32 s31, s21, 1
    s_add_u32 s30, s30, s31
    s_lshl_b32 s30, s30, 5
    s_lshl_b32 s31, s24, 2
    s_add_u32 s30, s30, s31
    s_lshl_b32 s31, s22, 1
    s_add_u32 s30, s30, s31
    s_lshl_b32 s30, s30, 12
    s_lshl_b32 s31, s35, 23
    s_add_u32 s30, s30, s31
    s_add_u32 s42, s30, 0
    buffer_store_dwordx4 v[64:67], v16, s[12:15], s42 offen offset:0
    buffer_store_dwordx4 v[68:71], v16, s[12:15], s42 offen offset:1024
    buffer_store_dwordx4 v[72:75], v16, s[12:15], s42 offen offset:2048
    buffer_store_dwordx4 v[76:79], v16, s[12:15], s42 offen offset:3072
    s_add_u32 s42, s30, 4096
    buffer_store_dwordx4 v[80:83], v16, s[12:15], s42 offen offset:0
    buffer_store_dwordx4 v[84:87], v16, s[12:15], s42 offen offset:1024
    buffer_store_dwordx4 v[88:91], v16, s[12:15], s42 offen offset:2048
    buffer_store_dwordx4 v[92:95], v16, s[12:15], s42 offen offset:3072
    s_add_u32 s42, s30, 131072
    buffer_store_dwordx4 v[96:99], v16, s[12:15], s42 offen offset:0
    buffer_store_dwordx4 v[100:103], v16, s[12:15], s42 offen offset:1024
    buffer_store_dwordx4 v[104:107], v16, s[12:15], s42 offen offset:2048
    buffer_store_dwordx4 v[108:111], v16, s[12:15], s42 offen offset:3072
    s_add_u32 s42, s30, 135168
    buffer_store_dwordx4 v[112:115], v16, s[12:15], s42 offen offset:0
    buffer_store_dwordx4 v[116:119], v16, s[12:15], s42 offen offset:1024
    buffer_store_dwordx4 v[120:123], v16, s[12:15], s42 offen offset:2048
    buffer_store_dwordx4 v[124:127], v16, s[12:15], s42 offen offset:3072
    s_endpgm
at_go:
    s_sub_u32 s30, s2, 256
    s_and_b32 s31, s30, 7
    s_lshr_b32 s30, s30, 3
    s_lshl_b32 s31, s31, 6
    s_add_u32 s30, s30, s31
    s_lshr_b32 s23, s30, 4
    s_and_b32 s24, s30, 15
    v_lshrrev_b32 v1, 6, v0
    v_and_b32 v0, 63, v0
    s_nop 0
    v_readfirstlane_b32 s20, v1
    s_lshr_b32 s21, s20, 1
    s_and_b32 s22, s20, 1
    s_waitcnt lgkmcnt(0)
    s_add_u32 s4, s64, 4194304
    s_addc_u32 s5, s65, 0
    s_mov_b32 s6, 12582912
    s_mov_b32 s7, 0x00020000
    s_add_u32 s12, s64, 16777216
    s_addc_u32 s13, s65, 0
    s_mov_b32 s14, 18874368
    s_mov_b32 s15, 0x00020000
    s_lshl_b32 s30, s24, 7
    s_lshl_b32 s31, s20, 5
    s_add_u32 s35, s30, s31
    v_and_b32 v1, 31, v0
    v_add_u32 v2, s35, v1
    v_lshlrev_b32 v2, 6, v2
    v_lshrrev_b32 v3, 5, v0
    v_lshl_add_u32 v2, v3, 4, v2
    s_lshl_b32 s36, s23, 17
    buffer_load_dwordx4 v[4:7], v2, s[4:7], s36 offen
    buffer_load_dwordx4 v[8:11], v2, s[4:7], s36 offen offset:32
    v_lshrrev_b32 v2, 2, v0
    v_lshlrev_b32 v2, 6, v2
    v_lshrrev_b32 v34, 4, v0
    v_and_b32 v35, 3, v0
    v_xor_b32 v35, v35, v34
    v_lshl_add_u32 v26, v35, 4, v2
    v_add_u32 v27, 1024, v26
    s_lshl_b32 s30, s20, 3
    v_and_b32 v35, 15, v0
    s_add_u32 s31, s30, 0
    v_add_u32 v2, s31, v34
    v_and_b32 v33, 15, v2
    v_xor_b32 v33, v33, v35
    v_lshlrev_b32 v2, 12, v2
    v_lshl_add_u32 v28, v33, 4, v2
    s_add_u32 s31, s30, 4
    v_add_u32 v2, s31, v34
    v_and_b32 v33, 15, v2
    v_xor_b32 v33, v33, v35
    v_lshlrev_b32 v2, 12, v2
    v_lshl_add_u32 v29, v33, 4, v2
    v_and_b32 v2, 0x13, v0
    v_bfe_u32 v33, v0, 2, 1
    v_lshl_or_b32 v2, v33, 3, v2
    v_bfe_u32 v33, v0, 3, 1
    v_lshl_or_b32 v2, v33, 2, v2
    v_bfe_u32 v33, v2, 2, 2
    v_lshlrev_b32 v2, 6, v2
    v_or_b32 v34, 0, v3
    v_xor_b32 v34, v34, v33
    v_lshl_add_u32 v16, v34, 4, v2
    v_or_b32 v34, 2, v3
    v_xor_b32 v34, v34, v33
    v_lshl_add_u32 v17, v34, 4, v2
    v_lshlrev_b32 v2, 8, v1
    v_and_b32 v33, 15, v0
    v_or_b32 v34, 0, v3
    v_xor_b32 v34, v34, v33
    v_lshl_add_u32 v18, v34, 4, v2
    v_or_b32 v34, 2, v3
    v_xor_b32 v34, v34, v33
    v_lshl_add_u32 v19, v34, 4, v2
    v_or_b32 v34, 4, v3
    v_xor_b32 v34, v34, v33
    v_lshl_add_u32 v20, v34, 4, v2
    v_or_b32 v34, 6, v3
    v_xor_b32 v34, v34, v33
    v_lshl_add_u32 v21, v34, 4, v2
    v_or_b32 v34, 8, v3
    v_xor_b32 v34, v34, v33
    v_lshl_add_u32 v22, v34, 4, v2
    v_or_b32 v34, 10, v3
    v_xor_b32 v34, v34, v33
    v_lshl_add_u32 v23, v34, 4, v2
    v_or_b32 v34, 12, v3
    v_xor_b32 v34, v34, v33
    v_lshl_add_u32 v24, v34, 4, v2
    v_or_b32 v34, 14, v3
    v_xor_b32 v34, v34, v33
    v_lshl_add_u32 v25, v34, 4, v2
    v_lshrrev_b32 v33, 2, v0
    v_lshrrev_b32 v34, 4, v0
    v_xor_b32 v33, v33, v34
    v_and_b32 v33, 1, v33
    v_and_b32 v34, 3, v0
    v_or_b32 v33, v33, v34
    v_cmp_eq_u32 vcc, 0, v33
    v_mov_b32 v34, 0x3f803f80
    v_cndmask_b32 v12, 0, v34, vcc
    v_cndmask_b32 v13, 0, v34, vcc
    v_cndmask_b32 v14, 0, v34, vcc
    v_cndmask_b32 v15, 0, v34, vcc
    s_lshl_b32 s32, s20, 11
    v_mov_b32 v84, 0
    v_mov_b32 v85, 0
    v_mov_b32 v86, 0
    v_mov_b32 v87, 0
    v_mov_b32 v88, 0
    v_mov_b32 v89, 0
    v_mov_b32 v90, 0
    v_mov_b32 v91, 0
    v_mov_b32 v92, 0
    v_mov_b32 v93, 0
    v_mov_b32 v94, 0
    v_mov_b32 v95, 0
    v_mov_b32 v96, 0
    v_mov_b32 v97, 0
    v_mov_b32 v98, 0
    v_mov_b32 v99, 0
    v_mov_b32 v100, 0
    v_mov_b32 v101, 0
    v_mov_b32 v102, 0
    v_mov_b32 v103, 0
    v_mov_b32 v104, 0
    v_mov_b32 v105, 0
    v_mov_b32 v106, 0
    v_mov_b32 v107, 0
    v_mov_b32 v108, 0
    v_mov_b32 v109, 0
    v_mov_b32 v110, 0
    v_mov_b32 v111, 0
    v_mov_b32 v112, 0
    v_mov_b32 v113, 0
    v_mov_b32 v114, 0
    v_mov_b32 v115, 0
    v_mov_b32 v116, 0
    v_mov_b32 v117, 0
    v_mov_b32 v118, 0
    v_mov_b32 v119, 0
    v_mov_b32 v120, 0
    v_mov_b32 v121, 0
    v_mov_b32 v122, 0
    v_mov_b32 v123, 0
    v_mov_b32 v124, 0
    v_mov_b32 v125, 0
    v_mov_b32 v126, 0
    v_mov_b32 v127, 0
    v_mov_b32 v128, 0
    v_mov_b32 v129, 0
    v_mov_b32 v130, 0
    v_mov_b32 v131, 0
    s_add_u32 s27, s36, 4194304
    s_add_u32 s27, s27, s32
    s_add_u32 s28, s36, 8388608
    s_mov_b32 s30, 0xff800000
    s_mov_b32 s31, 0xff800000
    s_mov_b32 s41, 1
    s_add_u32 m0, s32, 0
    s_nop 0
    buffer_load_dwordx4 v26, s[4:7], s27 offen lds
    s_add_u32 m0, s32, 1024
    s_nop 0
    buffer_load_dwordx4 v27, s[4:7], s27 offen lds
    s_add_u32 m0, s32, 8192
    s_nop 0
    buffer_load_dwordx4 v28, s[4:7], s28 offen lds
    s_add_u32 m0, s32, 9216
    s_nop 0
    buffer_load_dwordx4 v29, s[4:7], s28 offen lds
    s_add_u32 s27, s27, 8192
    s_add_u32 s28, s28, 256
    s_mov_b32 s29, 8
af_loop:
    s_waitcnt vmcnt(0)
    s_barrier
    s_add_u32 m0, s32, 16384
    s_nop 0
    buffer_load_dwordx4 v26, s[4:7], s27 offen lds
    s_add_u32 m0, s32, 17408
    s_nop 0
    buffer_load_dwordx4 v27, s[4:7], s27 offen lds
    s_add_u32 m0, s32, 24576
    s_nop 0
    buffer_load_dwordx4 v28, s[4:7], s28 offen lds
    s_add_u32 m0, s32, 25600
    s_nop 0
    buffer_load_dwordx4 v29, s[4:7], s28 offen lds
    s_add_u32 s27, s27, 8192
    s_add_u32 s28, s28, 256
    ds_read_b128 v[132:135], v16 offset:0
    ds_read_b128 v[136:139], v17 offset:0
    ds_read_b128 v[140:143], v16 offset:2048
    ds_read_b128 v[144:147], v17 offset:2048
    s_waitcnt lgkmcnt(2)
    v_mfma_f32_32x32x16_bf16 v[36:51], v[132:135], v[4:7], v[116:131]
    v_mfma_f32_32x32x16_bf16 v[36:51], v[136:139], v[8:11], v[36:51]
    s_waitcnt lgkmcnt(0)
    v_mfma_f32_32x32x16_bf16 v[52:67], v[140:143], v[4:7], v[116:131]
    v_mfma_f32_32x32x16_bf16 v[52:67], v[144:147], v[8:11], v[52:67]
    ds_read_b128 v[148:151], v18 offset:8192
    ds_read_b128 v[152:155], v19 offset:8192
    ds_read_b128 v[156:159], v20 offset:8192
    ds_read_b128 v[160:163], v21 offset:8192
    ds_read_b128 v[132:135], v16 offset:4096
    ds_read_b128 v[136:139], v17 offset:4096
    ds_read_b128 v[140:143], v16 offset:6144
    ds_read_b128 v[144:147], v17 offset:6144
    s_nop 1
    s_cmp_lg_u32 s41, 0
    s_cbranch_scc1 af00_first
af00_fast:
    v_exp_f32 v36, v36
    v_exp_f32 v37, v37
    v_exp_f32 v38, v38
    v_exp_f32 v39, v39
    v_exp_f32 v40, v40
    v_exp_f32 v41, v41
    v_exp_f32 v42, v42
    v_exp_f32 v43, v43
    v_exp_f32 v44, v44
    v_exp_f32 v45, v45
    v_exp_f32 v46, v46
    v_exp_f32 v47, v47
    v_exp_f32 v48, v48
    v_exp_f32 v49, v49
    v_exp_f32 v50, v50
    v_exp_f32 v51, v51
    v_cvt_pk_bf16_f32 v68, v36, v37
    v_cvt_pk_bf16_f32 v69, v38, v39
    v_cvt_pk_bf16_f32 v70, v40, v41
    v_cvt_pk_bf16_f32 v71, v42, v43
    s_waitcnt lgkmcnt(4)
    v_exp_f32 v52, v52
    v_exp_f32 v53, v53
    v_exp_f32 v54, v54
    v_exp_f32 v55, v55
    v_exp_f32 v56, v56
    v_exp_f32 v57, v57
    v_exp_f32 v58, v58
    v_exp_f32 v59, v59
    v_cvt_pk_bf16_f32 v72, v44, v45
    v_cvt_pk_bf16_f32 v73, v46, v47
    v_cvt_pk_bf16_f32 v74, v48, v49
    v_cvt_pk_bf16_f32 v75, v50, v51
    v_mfma_f32_32x32x16_bf16 v[84:99], v[148:151], v[68:71], v[84:99]
    v_mfma_f32_16x16x32_bf16 v[100:103], v[12:15], v[68:71], v[100:103]
    v_exp_f32 v60, v60
    v_exp_f32 v61, v61
    v_exp_f32 v62, v62
    v_exp_f32 v63, v63
    v_exp_f32 v64, v64
    v_exp_f32 v65, v65
    v_exp_f32 v66, v66
    v_exp_f32 v67, v67
    v_cvt_pk_bf16_f32 v76, v52, v53
    v_cvt_pk_bf16_f32 v77, v54, v55
    v_cvt_pk_bf16_f32 v78, v56, v57
    v_cvt_pk_bf16_f32 v79, v58, v59
    v_mfma_f32_32x32x16_bf16 v[84:99], v[152:155], v[72:75], v[84:99]
    v_mfma_f32_16x16x32_bf16 v[100:103], v[12:15], v[72:75], v[100:103]
    v_cvt_pk_bf16_f32 v80, v60, v61
    v_cvt_pk_bf16_f32 v81, v62, v63
    v_cvt_pk_bf16_f32 v82, v64, v65
    v_cvt_pk_bf16_f32 v83, v66, v67
    v_mfma_f32_32x32x16_bf16 v[84:99], v[156:159], v[76:79], v[84:99]
    v_mfma_f32_16x16x32_bf16 v[100:103], v[12:15], v[76:79], v[100:103]
    s_nop 1
    v_mfma_f32_32x32x16_bf16 v[84:99], v[160:163], v[80:83], v[84:99]
    v_mfma_f32_16x16x32_bf16 v[100:103], v[12:15], v[80:83], v[100:103]
    s_waitcnt lgkmcnt(2)
    v_mfma_f32_32x32x16_bf16 v[36:51], v[132:135], v[4:7], v[116:131]
    v_mfma_f32_32x32x16_bf16 v[36:51], v[136:139], v[8:11], v[36:51]
    s_waitcnt lgkmcnt(0)
    v_mfma_f32_32x32x16_bf16 v[52:67], v[140:143], v[4:7], v[116:131]
    v_mfma_f32_32x32x16_bf16 v[52:67], v[144:147], v[8:11], v[52:67]
    ds_read_b128 v[148:151], v22 offset:8192
    ds_read_b128 v[152:155], v23 offset:8192
    ds_read_b128 v[156:159], v24 offset:8192
    ds_read_b128 v[160:163], v25 offset:8192
    s_nop 5
af01_fast:
    v_exp_f32 v36, v36
    v_exp_f32 v37, v37
    v_exp_f32 v38, v38
    v_exp_f32 v39, v39
    v_exp_f32 v40, v40
    v_exp_f32 v41, v41
    v_exp_f32 v42, v42
    v_exp_f32 v43, v43
    v_exp_f32 v44, v44
    v_exp_f32 v45, v45
    v_exp_f32 v46, v46
    v_exp_f32 v47, v47
    v_exp_f32 v48, v48
    v_exp_f32 v49, v49
    v_exp_f32 v50, v50
    v_exp_f32 v51, v51
    v_cvt_pk_bf16_f32 v68, v36, v37
    v_cvt_pk_bf16_f32 v69, v38, v39
    v_cvt_pk_bf16_f32 v70, v40, v41
    v_cvt_pk_bf16_f32 v71, v42, v43
    s_waitcnt lgkmcnt(0)
    v_exp_f32 v52, v52
    v_exp_f32 v53, v53
    v_exp_f32 v54, v54
    v_exp_f32 v55, v55
    v_exp_f32 v56, v56
    v_exp_f32 v57, v57
    v_exp_f32 v58, v58
    v_exp_f32 v59, v59
    v_cvt_pk_bf16_f32 v72, v44, v45
    v_cvt_pk_bf16_f32 v73, v46, v47
    v_cvt_pk_bf16_f32 v74, v48, v49
    v_cvt_pk_bf16_f32 v75, v50, v51
    v_mfma_f32_32x32x16_bf16 v[84:99], v[148:151], v[68:71], v[84:99]
    v_mfma_f32_16x16x32_bf16 v[100:103], v[12:15], v[68:71], v[100:103]
    v_exp_f32 v60, v60
    v_exp_f32 v61, v61
    v_exp_f32 v62, v62
    v_exp_f32 v63, v63
    v_exp_f32 v64, v64
    v_exp_f32 v65, v65
    v_exp_f32 v66, v66
    v_exp_f32 v67, v67
    v_cvt_pk_bf16_f32 v76, v52, v53
    v_cvt_pk_bf16_f32 v77, v54, v55
    v_cvt_pk_bf16_f32 v78, v56, v57
    v_cvt_pk_bf16_f32 v79, v58, v59
    v_mfma_f32_32x32x16_bf16 v[84:99], v[152:155], v[72:75], v[84:99]
    v_mfma_f32_16x16x32_bf16 v[100:103], v[12:15], v[72:75], v[100:103]
    v_cvt_pk_bf16_f32 v80, v60, v61
    v_cvt_pk_bf16_f32 v81, v62, v63
    v_cvt_pk_bf16_f32 v82, v64, v65
    v_cvt_pk_bf16_f32 v83, v66, v67
    v_mfma_f32_32x32x16_bf16 v[84:99], v[156:159], v[76:79], v[84:99]
    v_mfma_f32_16x16x32_bf16 v[100:103], v[12:15], v[76:79], v[100:103]
    s_nop 1
    v_mfma_f32_32x32x16_bf16 v[84:99], v[160:163], v[80:83], v[84:99]
    v_mfma_f32_16x16x32_bf16 v[100:103], v[12:15], v[80:83], v[100:103]
    s_waitcnt vmcnt(0)
    s_barrier
    s_sub_u32 s29, s29, 1
    s_cmp_eq_u32 s29, 0
    s_cbranch_scc1 af_nold
    s_add_u32 m0, s32, 0
    s_nop 0
    buffer_load_dwordx4 v26, s[4:7], s27 offen lds
    s_add_u32 m0, s32, 1024
    s_nop 0
    buffer_load_dwordx4 v27, s[4:7], s27 offen lds
    s_add_u32 m0, s32, 8192
    s_nop 0
    buffer_load_dwordx4 v28, s[4:7], s28 offen lds
    s_add_u32 m0, s32, 9216
    s_nop 0
    buffer_load_dwordx4 v29, s[4:7], s28 offen lds
    s_add_u32 s27, s27, 8192
    s_add_u32 s28, s28, 256
af_nold:
    ds_read_b128 v[132:135], v16 offset:16384
    ds_read_b128 v[136:139], v17 offset:16384
    ds_read_b128 v[140:143], v16 offset:18432
    ds_read_b128 v[144:147], v17 offset:18432
    s_waitcnt lgkmcnt(2)
    v_mfma_f32_32x32x16_bf16 v[36:51], v[132:135], v[4:7], v[116:131]
    v_mfma_f32_32x32x16_bf16 v[36:51], v[136:139], v[8:11], v[36:51]
    s_waitcnt lgkmcnt(0)
    v_mfma_f32_32x32x16_bf16 v[52:67], v[140:143], v[4:7], v[116:131]
    v_mfma_f32_32x32x16_bf16 v[52:67], v[144:147], v[8:11], v[52:67]
    ds_read_b128 v[148:151], v18 offset:24576
    ds_read_b128 v[152:155], v19 offset:24576
    ds_read_b128 v[156:159], v20 offset:24576
    ds_read_b128 v[160:163], v21 offset:24576
    ds_read_b128 v[132:135], v16 offset:20480
    ds_read_b128 v[136:139], v17 offset:20480
    ds_read_b128 v[140:143], v16 offset:22528
    ds_read_b128 v[144:147], v17 offset:22528
    s_nop 1
af10_fast:
    v_exp_f32 v36, v36
    v_exp_f32 v37, v37
    v_exp_f32 v38, v38
    v_exp_f32 v39, v39
    v_exp_f32 v40, v40
    v_exp_f32 v41, v41
    v_exp_f32 v42, v42
    v_exp_f32 v43, v43
    v_exp_f32 v44, v44
    v_exp_f32 v45, v45
    v_exp_f32 v46, v46
    v_exp_f32 v47, v47
    v_exp_f32 v48, v48
    v_exp_f32 v49, v49
    v_exp_f32 v50, v50
    v_exp_f32 v51, v51
    v_cvt_pk_bf16_f32 v68, v36, v37
    v_cvt_pk_bf16_f32 v69, v38, v39
    v_cvt_pk_bf16_f32 v70, v40, v41
    v_cvt_pk_bf16_f32 v71, v42, v43
    s_waitcnt lgkmcnt(4)
    v_exp_f32 v52, v52
    v_exp_f32 v53, v53
    v_exp_f32 v54, v54
    v_exp_f32 v55, v55
    v_exp_f32 v56, v56
    v_exp_f32 v57, v57
    v_exp_f32 v58, v58
    v_exp_f32 v59, v59
    v_cvt_pk_bf16_f32 v72, v44, v45
    v_cvt_pk_bf16_f32 v73, v46, v47
    v_cvt_pk_bf16_f32 v74, v48, v49
    v_cvt_pk_bf16_f32 v75, v50, v51
    v_mfma_f32_32x32x16_bf16 v[84:99], v[148:151], v[68:71], v[84:99]
    v_mfma_f32_16x16x32_bf16 v[100:103], v[12:15], v[68:71], v[100:103]
    v_exp_f32 v60, v60
    v_exp_f32 v61, v61
    v_exp_f32 v62, v62
    v_exp_f32 v63, v63
    v_exp_f32 v64, v64
    v_exp_f32 v65, v65
    v_exp_f32 v66, v66
    v_exp_f32 v67, v67
    v_cvt_pk_bf16_f32 v76, v52, v53
    v_cvt_pk_bf16_f32 v77, v54, v55
    v_cvt_pk_bf16_f32 v78, v56, v57
    v_cvt_pk_bf16_f32 v79, v58, v59
    v_mfma_f32_32x32x16_bf16 v[84:99], v[152:155], v[72:75], v[84:99]
    v_mfma_f32_16x16x32_bf16 v[100:103], v[12:15], v[72:75], v[100:103]
    v_cvt_pk_bf16_f32 v80, v60, v61
    v_cvt_pk_bf16_f32 v81, v62, v63
    v_cvt_pk_bf16_f32 v82, v64, v65
    v_cvt_pk_bf16_f32 v83, v66, v67
    v_mfma_f32_32x32x16_bf16 v[84:99], v[156:159], v[76:79], v[84:99]
    v_mfma_f32_16x16x32_bf16 v[100:103], v[12:15], v[76:79], v[100:103]
    s_nop 1
    v_mfma_f32_32x32x16_bf16 v[84:99], v[160:163], v[80:83], v[84:99]
    v_mfma_f32_16x16x32_bf16 v[100:103], v[12:15], v[80:83], v[100:103]
    s_waitcnt lgkmcnt(2)
    v_mfma_f32_32x32x16_bf16 v[36:51], v[132:135], v[4:7], v[116:131]
    v_mfma_f32_32x32x16_bf16 v[36:51], v[136:139], v[8:11], v[36:51]
    s_waitcnt lgkmcnt(0)
    v_mfma_f32_32x32x16_bf16 v[52:67], v[140:143], v[4:7], v[116:131]
    v_mfma_f32_32x32x16_bf16 v[52:67], v[144:147], v[8:11], v[52:67]
    ds_read_b128 v[148:151], v22 offset:24576
    ds_read_b128 v[152:155], v23 offset:24576
    ds_read_b128 v[156:159], v24 offset:24576
    ds_read_b128 v[160:163], v25 offset:24576
    s_nop 5
af11_fast:
    v_exp_f32 v36, v36
    v_exp_f32 v37, v37
    v_exp_f32 v38, v38
    v_exp_f32 v39, v39
    v_exp_f32 v40, v40
    v_exp_f32 v41, v41
    v_exp_f32 v42, v42
    v_exp_f32 v43, v43
    v_exp_f32 v44, v44
    v_exp_f32 v45, v45
    v_exp_f32 v46, v46
    v_exp_f32 v47, v47
    v_exp_f32 v48, v48
    v_exp_f32 v49, v49
    v_exp_f32 v50, v50
    v_exp_f32 v51, v51
    v_cvt_pk_bf16_f32 v68, v36, v37
    v_cvt_pk_bf16_f32 v69, v38, v39
    v_cvt_pk_bf16_f32 v70, v40, v41
    v_cvt_pk_bf16_f32 v71, v42, v43
    s_waitcnt lgkmcnt(0)
    v_exp_f32 v52, v52
    v_exp_f32 v53, v53
    v_exp_f32 v54, v54
    v_exp_f32 v55, v55
    v_exp_f32 v56, v56
    v_exp_f32 v57, v57
    v_exp_f32 v58, v58
    v_exp_f32 v59, v59
    v_cvt_pk_bf16_f32 v72, v44, v45
    v_cvt_pk_bf16_f32 v73, v46, v47
    v_cvt_pk_bf16_f32 v74, v48, v49
    v_cvt_pk_bf16_f32 v75, v50, v51
    v_mfma_f32_32x32x16_bf16 v[84:99], v[148:151], v[68:71], v[84:99]
    v_mfma_f32_16x16x32_bf16 v[100:103], v[12:15], v[68:71], v[100:103]
    v_exp_f32 v60, v60
    v_exp_f32 v61, v61
    v_exp_f32 v62, v62
    v_exp_f32 v63, v63
    v_exp_f32 v64, v64
    v_exp_f32 v65, v65
    v_exp_f32 v66, v66
    v_exp_f32 v67, v67
    v_cvt_pk_bf16_f32 v76, v52, v53
    v_cvt_pk_bf16_f32 v77, v54, v55
    v_cvt_pk_bf16_f32 v78, v56, v57
    v_cvt_pk_bf16_f32 v79, v58, v59
    v_mfma_f32_32x32x16_bf16 v[84:99], v[152:155], v[72:75], v[84:99]
    v_mfma_f32_16x16x32_bf16 v[100:103], v[12:15], v[72:75], v[100:103]
    v_cvt_pk_bf16_f32 v80, v60, v61
    v_cvt_pk_bf16_f32 v81, v62, v63
    v_cvt_pk_bf16_f32 v82, v64, v65
    v_cvt_pk_bf16_f32 v83, v66, v67
    v_mfma_f32_32x32x16_bf16 v[84:99], v[156:159], v[76:79], v[84:99]
    v_mfma_f32_16x16x32_bf16 v[100:103], v[12:15], v[76:79], v[100:103]
    s_nop 1
    v_mfma_f32_32x32x16_bf16 v[84:99], v[160:163], v[80:83], v[84:99]
    v_mfma_f32_16x16x32_bf16 v[100:103], v[12:15], v[80:83], v[100:103]
    s_cmp_lg_u32 s29, 0
    s_cbranch_scc1 af_loop
    s_nop 15
    s_nop 3
    s_mov_b32 s42, 0x5d800000
    v_cmp_nle_f32 vcc, v100, s42
    s_cmp_lg_u64 vcc, 0
    s_cselect_b32 s43, 1, 0
    s_lshl_b32 s42, s20, 2
    v_mov_b32 v33, s42
    v_mov_b32 v34, s43
    s_barrier
    ds_write_b32 v33, v34
    v_mov_b32 v33, 0
    s_waitcnt lgkmcnt(0)
    s_barrier
    ds_read_b128 v[36:39], v33
    s_waitcnt lgkmcnt(0)
    v_or3_b32 v33, v36, v37, v38
    v_or_b32 v33, v33, v39
    s_nop 1
    v_readfirstlane_b32 s43, v33
    s_cmp_lg_u32 s43, 0
    s_cbranch_scc1 at_safe
at_epi:
    v_rcp_f32 v33, v100
    s_mov_b32 s30, 9216
    v_add_u32 v2, s35, v1
    v_mul_lo_u32 v2, v2, s30
    v_lshl_add_u32 v2, v3, 3, v2
    s_lshl_b32 s31, s23, 6
    v_mul_f32 v84, v84, v33
    v_mul_f32 v85, v85, v33
    v_mul_f32 v86, v86, v33
    v_mul_f32 v87, v87, v33
    v_cvt_pk_bf16_f32 v36, v84, v85
    v_cvt_pk_bf16_f32 v37, v86, v87
    buffer_store_dwordx2 v[36:37], v2, s[12:15], s31 offen offset:0
    v_mul_f32 v88, v88, v33
    v_mul_f32 v89, v89, v33
    v_mul_f32 v90, v90, v33
    v_mul_f32 v91, v91, v33
    v_cvt_pk_bf16_f32 v38, v88, v89
    v_cvt_pk_bf16_f32 v39, v90, v91
    buffer_store_dwordx2 v[38:39], v2, s[12:15], s31 offen offset:16
    v_mul_f32 v92, v92, v33
    v_mul_f32 v93, v93, v33
    v_mul_f32 v94, v94, v33
    v_mul_f32 v95, v95, v33
    v_cvt_pk_bf16_f32 v40, v92, v93
    v_cvt_pk_bf16_f32 v41, v94, v95
    buffer_store_dwordx2 v[40:41], v2, s[12:15], s31 offen offset:32
    v_mul_f32 v96, v96, v33
    v_mul_f32 v97, v97, v33
    v_mul_f32 v98, v98, v33
    v_mul_f32 v99, v99, v33
    v_cvt_pk_bf16_f32 v42, v96, v97
    v_cvt_pk_bf16_f32 v43, v98, v99
    buffer_store_dwordx2 v[42:43], v2, s[12:15], s31 offen offset:48
    s_endpgm
af00_first:
    v_max3_f32 v30, v36, v37, v38
    v_max3_f32 v30, v30, v39, v40
    v_max3_f32 v30, v30, v41, v42
    v_max3_f32 v30, v30, v43, v44
    v_max3_f32 v30, v30, v45, v46
    v_max3_f32 v30, v30, v47, v48
    v_max3_f32 v30, v30, v49, v50
    v_max3_f32 v30, v30, v51, v52
    v_max3_f32 v30, v30, v53, v54
    v_max3_f32 v30, v30, v55, v56
    v_max3_f32 v30, v30, v57, v58
    v_max3_f32 v30, v30, v59, v60
    v_max3_f32 v30, v30, v61, v62
    v_max3_f32 v30, v30, v63, v64
    v_max3_f32 v30, v30, v65, v66
    v_max_f32 v30, v30, v67
    s_mov_b32 s41, 0
af00_slow:
    v_mov_b32 v31, v30
    s_nop 1
    v_permlane32_swap_b32 v30, v31
    s_nop 1
    v_max3_f32 v32, v30, v31, s31
    v_max_f32 v33, 0, v32
    v_exp_f32 v33, -v33
    v_sub_f32 v116, v116, v32
    v_sub_f32 v36, v36, v32
    v_sub_f32 v37, v37, v32
    v_sub_f32 v38, v38, v32
    v_sub_f32 v39, v39, v32
    v_sub_f32 v40, v40, v32
    v_sub_f32 v41, v41, v32
    v_sub_f32 v42, v42, v32
    v_sub_f32 v43, v43, v32
    v_sub_f32 v44, v44, v32
    v_sub_f32 v45, v45, v32
    v_sub_f32 v46, v46, v32
    v_sub_f32 v47, v47, v32
    v_sub_f32 v48, v48, v32
    v_sub_f32 v49, v49, v32
    v_sub_f32 v50, v50, v32
    v_sub_f32 v51, v51, v32
    v_sub_f32 v52, v52, v32
    v_sub_f32 v53, v53, v32
    v_sub_f32 v54, v54, v32
    v_sub_f32 v55, v55, v32
    v_sub_f32 v56, v56, v32
    v_sub_f32 v57, v57, v32
    v_sub_f32 v58, v58, v32
    v_sub_f32 v59, v59, v32
    v_sub_f32 v60, v60, v32
    v_sub_f32 v61, v61, v32
    v_sub_f32 v62, v62, v32
    v_sub_f32 v63, v63, v32
    v_sub_f32 v64, v64, v32
    v_sub_f32 v65, v65, v32
    v_sub_f32 v66, v66, v32
    v_sub_f32 v67, v67, v32
    v_mul_f32 v84, v84, v33
    v_mul_f32 v85, v85, v33
    v_mul_f32 v86, v86, v33
    v_mul_f32 v87, v87, v33
    v_mul_f32 v88, v88, v33
    v_mul_f32 v89, v89, v33
    v_mul_f32 v90, v90, v33
    v_mul_f32 v91, v91, v33
    v_mul_f32 v92, v92, v33
    v_mul_f32 v93, v93, v33
    v_mul_f32 v94, v94, v33
    v_mul_f32 v95, v95, v33
    v_mul_f32 v96, v96, v33
    v_mul_f32 v97, v97, v33
    v_mul_f32 v98, v98, v33
    v_mul_f32 v99, v99, v33
    v_mul_f32 v100, v100, v33
    v_mov_b32 v117, v116
    v_mov_b32 v118, v116
    v_mov_b32 v119, v116
    v_mov_b32 v120, v116
    v_mov_b32 v121, v116
    v_mov_b32 v122, v116
    v_mov_b32 v123, v116
    v_mov_b32 v124, v116
    v_mov_b32 v125, v116
    v_mov_b32 v126, v116
    v_mov_b32 v127, v116
    v_mov_b32 v128, v116
    v_mov_b32 v129, v116
    v_mov_b32 v130, v116
    v_mov_b32 v131, v116
    s_mov_b32 s30, 0x41000000
    s_mov_b32 s31, 0
    s_branch af00_fast
at_safe:
    s_barrier
    v_mov_b32 v84, 0
    v_mov_b32 v85, 0
    v_mov_b32 v86, 0
    v_mov_b32 v87, 0
    v_mov_b32 v88, 0
    v_mov_b32 v89, 0
    v_mov_b32 v90, 0
    v_mov_b32 v91, 0
    v_mov_b32 v92, 0
    v_mov_b32 v93, 0
    v_mov_b32 v94, 0
    v_mov_b32 v95, 0
    v_mov_b32 v96, 0
    v_mov_b32 v97, 0
    v_mov_b32 v98, 0
    v_mov_b32 v99, 0
    v_mov_b32 v100, 0
    v_mov_b32 v101, 0
    v_mov_b32 v102, 0
    v_mov_b32 v103, 0
    v_mov_b32 v104, 0
    v_mov_b32 v105, 0
    v_mov_b32 v106, 0
    v_mov_b32 v107, 0
    v_mov_b32 v108, 0
    v_mov_b32 v109, 0
    v_mov_b32 v110, 0
    v_mov_b32 v111, 0
    v_mov_b32 v112, 0
    v_mov_b32 v113, 0
    v_mov_b32 v114, 0
    v_mov_b32 v115, 0
    v_mov_b32 v116, 0
    v_mov_b32 v117, 0
    v_mov_b32 v118, 0
    v_mov_b32 v119, 0
    v_mov_b32 v120, 0
    v_mov_b32 v121, 0
    v_mov_b32 v122, 0
    v_mov_b32 v123, 0
    v_mov_b32 v124, 0
    v_mov_b32 v125, 0
    v_mov_b32 v126, 0
    v_mov_b32 v127, 0
    v_mov_b32 v128, 0
    v_mov_b32 v129, 0
    v_mov_b32 v130, 0
    v_mov_b32 v131, 0
    s_add_u32 s27, s36, 4194304
    s_add_u32 s27, s27, s32
    s_add_u32 s28, s36, 8388608
    s_mov_b32 s30, 0xff800000
    s_mov_b32 s31, 0xff800000
    s_mov_b32 s41, 1
    s_add_u32 m0, s32, 0
    s_nop 0
    buffer_load_dwordx4 v26, s[4:7], s27 offen lds
    s_add_u32 m0, s32, 1024
    s_nop 0
    buffer_load_dwordx4 v27, s[4:7], s27 offen lds
    s_add_u32 m0, s32, 8192
    s_nop 0
    buffer_load_dwordx4 v28, s[4:7], s28 offen lds
    s_add_u32 m0, s32, 9216
    s_nop 0
    buffer_load_dwordx4 v29, s[4:7], s28 offen lds
    s_add_u32 s27, s27, 8192
    s_add_u32 s28, s28, 256
    s_mov_b32 s29, 8
as_loop:
    s_waitcnt vmcnt(0)
    s_barrier
    s_add_u32 m0, s32, 16384
    s_nop 0
    buffer_load_dwordx4 v26, s[4:7], s27 offen lds
    s_add_u32 m0, s32, 17408
    s_nop 0
    buffer_load_dwordx4 v27, s[4:7], s27 offen lds
    s_add_u32 m0, s32, 24576
    s_nop 0
    buffer_load_dwordx4 v28, s[4:7], s28 offen lds
    s_add_u32 m0, s32, 25600
    s_nop 0
    buffer_load_dwordx4 v29, s[4:7], s28 offen lds
    s_add_u32 s27, s27, 8192
    s_add_u32 s28, s28, 256
    ds_read_b128 v[132:135], v16 offset:0
    ds_read_b128 v[136:139], v17 offset:0
    ds_read_b128 v[140:143], v16 offset:2048
    ds_read_b128 v[144:147], v17 offset:2048
    s_waitcnt lgkmcnt(2)
    v_mfma_f32_32x32x16_bf16 v[36:51], v[132:135], v[4:7], v[116:131]
    v_mfma_f32_32x32x16_bf16 v[36:51], v[136:139], v[8:11], v[36:51]
    s_waitcnt lgkmcnt(0)
    v_mfma_f32_32x32x16_bf16 v[52:67], v[140:143], v[4:7], v[116:131]
    v_mfma_f32_32x32x16_bf16 v[52:67], v[144:147], v[8:11], v[52:67]
    ds_read_b128 v[148:151], v18 offset:8192
    ds_read_b128 v[152:155], v19 offset:8192
    ds_read_b128 v[156:159], v20 offset:8192
    ds_read_b128 v[160:163], v21 offset:8192
    ds_read_b128 v[132:135], v16 offset:4096
    ds_read_b128 v[136:139], v17 offset:4096
    ds_read_b128 v[140:143], v16 offset:6144
    ds_read_b128 v[144:147], v17 offset:6144
    s_nop 1
    v_max3_f32 v30, v36, v37, v38
    v_max3_f32 v30, v30, v39, v40
    v_max3_f32 v30, v30, v41, v42
    v_max3_f32 v30, v30, v43, v44
    v_max3_f32 v30, v30, v45, v46
    v_max3_f32 v30, v30, v47, v48
    v_max3_f32 v30, v30, v49, v50
    v_max3_f32 v30, v30, v51, v52
    v_max3_f32 v30, v30, v53, v54
    v_max3_f32 v30, v30, v55, v56
    v_max3_f32 v30, v30, v57, v58
    v_max3_f32 v30, v30, v59, v60
    v_max3_f32 v30, v30, v61, v62
    v_max3_f32 v30, v30, v63, v64
    v_max3_f32 v30, v30, v65, v66
    v_max_f32 v30, v30, v67
    v_cmp_lt_f32 vcc, s30, v30
    s_cbranch_vccnz as00_slow
as00_fast:
    v_exp_f32 v36, v36
    v_exp_f32 v37, v37
    v_exp_f32 v38, v38
    v_exp_f32 v39, v39
    v_exp_f32 v40, v40
    v_exp_f32 v41, v41
    v_exp_f32 v42, v42
    v_exp_f32 v43, v43
    v_exp_f32 v44, v44
    v_exp_f32 v45, v45
    v_exp_f32 v46, v46
    v_exp_f32 v47, v47
    v_exp_f32 v48, v48
    v_exp_f32 v49, v49
    v_exp_f32 v50, v50
    v_exp_f32 v51, v51
    v_cvt_pk_bf16_f32 v68, v36, v37
    v_cvt_pk_bf16_f32 v69, v38, v39
    v_cvt_pk_bf16_f32 v70, v40, v41
    v_cvt_pk_bf16_f32 v71, v42, v43
    s_waitcnt lgkmcnt(4)
    v_exp_f32 v52, v52
    v_exp_f32 v53, v53
    v_exp_f32 v54, v54
    v_exp_f32 v55, v55
    v_exp_f32 v56, v56
    v_exp_f32 v57, v57
    v_exp_f32 v58, v58
    v_exp_f32 v59, v59
    v_cvt_pk_bf16_f32 v72, v44, v45
    v_cvt_pk_bf16_f32 v73, v46, v47
    v_cvt_pk_bf16_f32 v74, v48, v49
    v_cvt_pk_bf16_f32 v75, v50, v51
    v_mfma_f32_32x32x16_bf16 v[84:99], v[148:151], v[68:71], v[84:99]
    v_mfma_f32_16x16x32_bf16 v[100:103], v[12:15], v[68:71], v[100:103]
    v_exp_f32 v60, v60
    v_exp_f32 v61, v61
    v_exp_f32 v62, v62
    v_exp_f32 v63, v63
    v_exp_f32 v64, v64
    v_exp_f32 v65, v65
    v_exp_f32 v66, v66
    v_exp_f32 v67, v67
    v_cvt_pk_bf16_f32 v76, v52, v53
    v_cvt_pk_bf16_f32 v77, v54, v55
    v_cvt_pk_bf16_f32 v78, v56, v57
    v_cvt_pk_bf16_f32 v79, v58, v59
    v_mfma_f32_32x32x16_bf16 v[84:99], v[152:155], v[72:75], v[84:99]
    v_mfma_f32_16x16x32_bf16 v[100:103], v[12:15], v[72:75], v[100:103]
    v_cvt_pk_bf16_f32 v80, v60, v61
    v_cvt_pk_bf16_f32 v81, v62, v63
    v_cvt_pk_bf16_f32 v82, v64, v65
    v_cvt_pk_bf16_f32 v83, v66, v67
    v_mfma_f32_32x32x16_bf16 v[84:99], v[156:159], v[76:79], v[84:99]
    v_mfma_f32_16x16x32_bf16 v[100:103], v[12:15], v[76:79], v[100:103]
    s_nop 1
    v_mfma_f32_32x32x16_bf16 v[84:99], v[160:163], v[80:83], v[84:99]
    v_mfma_f32_16x16x32_bf16 v[100:103], v[12:15], v[80:83], v[100:103]
    s_waitcnt lgkmcnt(2)
    v_mfma_f32_32x32x16_bf16 v[36:51], v[132:135], v[4:7], v[116:131]
    v_mfma_f32_32x32x16_bf16 v[36:51], v[136:139], v[8:11], v[36:51]
    s_waitcnt lgkmcnt(0)
    v_mfma_f32_32x32x16_bf16 v[52:67], v[140:143], v[4:7], v[116:131]
    v_mfma_f32_32x32x16_bf16 v[52:67], v[144:147], v[8:11], v[52:67]
    ds_read_b128 v[148:151], v22 offset:8192
    ds_read_b128 v[152:155], v23 offset:8192
    ds_read_b128 v[156:159], v24 offset:8192
    ds_read_b128 v[160:163], v25 offset:8192
    s_nop 5
    v_max3_f32 v30, v36, v37, v38
    v_max3_f32 v30, v30, v39, v40
    v_max3_f32 v30, v30, v41, v42
    v_max3_f32 v30, v30, v43, v44
    v_max3_f32 v30, v30, v45, v46
    v_max3_f32 v30, v30, v47, v48
    v_max3_f32 v30, v30, v49, v50
    v_max3_f32 v30, v30, v51, v52
    v_max3_f32 v30, v30, v53, v54
    v_max3_f32 v30, v30, v55, v56
    v_max3_f32 v30, v30, v57, v58
    v_max3_f32 v30, v30, v59, v60
    v_max3_f32 v30, v30, v61, v62
    v_max3_f32 v30, v30, v63, v64
    v_max3_f32 v30, v30, v65, v66
    v_max_f32 v30, v30, v67
    v_cmp_lt_f32 vcc, s30, v30
    s_cbranch_vccnz as01_slow
as01_fast:
    v_exp_f32 v36, v36
    v_exp_f32 v37, v37
    v_exp_f32 v38, v38
    v_exp_f32 v39, v39
    v_exp_f32 v40, v40
    v_exp_f32 v41, v41
    v_exp_f32 v42, v42
    v_exp_f32 v43, v43
    v_exp_f32 v44, v44
    v_exp_f32 v45, v45
    v_exp_f32 v46, v46
    v_exp_f32 v47, v47
    v_exp_f32 v48, v48
    v_exp_f32 v49, v49
    v_exp_f32 v50, v50
    v_exp_f32 v51, v51
    v_cvt_pk_bf16_f32 v68, v36, v37
    v_cvt_pk_bf16_f32 v69, v38, v39
    v_cvt_pk_bf16_f32 v70, v40, v41
    v_cvt_pk_bf16_f32 v71, v42, v43
    s_waitcnt lgkmcnt(0)
    v_exp_f32 v52, v52
    v_exp_f32 v53, v53
    v_exp_f32 v54, v54
    v_exp_f32 v55, v55
    v_exp_f32 v56, v56
    v_exp_f32 v57, v57
    v_exp_f32 v58, v58
    v_exp_f32 v59, v59
    v_cvt_pk_bf16_f32 v72, v44, v45
    v_cvt_pk_bf16_f32 v73, v46, v47
    v_cvt_pk_bf16_f32 v74, v48, v49
    v_cvt_pk_bf16_f32 v75, v50, v51
    v_mfma_f32_32x32x16_bf16 v[84:99], v[148:151], v[68:71], v[84:99]
    v_mfma_f32_16x16x32_bf16 v[100:103], v[12:15], v[68:71], v[100:103]
    v_exp_f32 v60, v60
    v_exp_f32 v61, v61
    v_exp_f32 v62, v62
    v_exp_f32 v63, v63
    v_exp_f32 v64, v64
    v_exp_f32 v65, v65
    v_exp_f32 v66, v66
    v_exp_f32 v67, v67
    v_cvt_pk_bf16_f32 v76, v52, v53
    v_cvt_pk_bf16_f32 v77, v54, v55
    v_cvt_pk_bf16_f32 v78, v56, v57
    v_cvt_pk_bf16_f32 v79, v58, v59
    v_mfma_f32_32x32x16_bf16 v[84:99], v[152:155], v[72:75], v[84:99]
    v_mfma_f32_16x16x32_bf16 v[100:103], v[12:15], v[72:75], v[100:103]
    v_cvt_pk_bf16_f32 v80, v60, v61
    v_cvt_pk_bf16_f32 v81, v62, v63
    v_cvt_pk_bf16_f32 v82, v64, v65
    v_cvt_pk_bf16_f32 v83, v66, v67
    v_mfma_f32_32x32x16_bf16 v[84:99], v[156:159], v[76:79], v[84:99]
    v_mfma_f32_16x16x32_bf16 v[100:103], v[12:15], v[76:79], v[100:103]
    s_nop 1
    v_mfma_f32_32x32x16_bf16 v[84:99], v[160:163], v[80:83], v[84:99]
    v_mfma_f32_16x16x32_bf16 v[100:103], v[12:15], v[80:83], v[100:103]
    s_waitcnt vmcnt(0)
    s_barrier
    s_sub_u32 s29, s29, 1
    s_cmp_eq_u32 s29, 0
    s_cbranch_scc1 as_nold
    s_add_u32 m0, s32, 0
    s_nop 0
    buffer_load_dwordx4 v26, s[4:7], s27 offen lds
    s_add_u32 m0, s32, 1024
    s_nop 0
    buffer_load_dwordx4 v27, s[4:7], s27 offen lds
    s_add_u32 m0, s32, 8192
    s_nop 0
    buffer_load_dwordx4 v28, s[4:7], s28 offen lds
    s_add_u32 m0, s32, 9216
    s_nop 0
    buffer_load_dwordx4 v29, s[4:7], s28 offen lds
    s_add_u32 s27, s27, 8192
    s_add_u32 s28, s28, 256
as_nold:
    ds_read_b128 v[132:135], v16 offset:16384
    ds_read_b128 v[136:139], v17 offset:16384
    ds_read_b128 v[140:143], v16 offset:18432
    ds_read_b128 v[144:147], v17 offset:18432
    s_waitcnt lgkmcnt(2)
    v_mfma_f32_32x32x16_bf16 v[36:51], v[132:135], v[4:7], v[116:131]
    v_mfma_f32_32x32x16_bf16 v[36:51], v[136:139], v[8:11], v[36:51]
    s_waitcnt lgkmcnt(0)
    v_mfma_f32_32x32x16_bf16 v[52:67], v[140:143], v[4:7], v[116:131]
    v_mfma_f32_32x32x16_bf16 v[52:67], v[144:147], v[8:11], v[52:67]
    ds_read_b128 v[148:151], v18 offset:24576
    ds_read_b128 v[152:155], v19 offset:24576
    ds_read_b128 v[156:159], v20 offset:24576
    ds_read_b128 v[160:163], v21 offset:24576
    ds_read_b128 v[132:135], v16 offset:20480
    ds_read_b128 v[136:139], v17 offset:20480
    ds_read_b128 v[140:143], v16 offset:22528
    ds_read_b128 v[144:147], v17 offset:22528
    s_nop 1
    v_max3_f32 v30, v36, v37, v38
    v_max3_f32 v30, v30, v39, v40
    v_max3_f32 v30, v30, v41, v42
    v_max3_f32 v30, v30, v43, v44
    v_max3_f32 v30, v30, v45, v46
    v_max3_f32 v30, v30, v47, v48
    v_max3_f32 v30, v30, v49, v50
    v_max3_f32 v30, v30, v51, v52
    v_max3_f32 v30, v30, v53, v54
    v_max3_f32 v30, v30, v55, v56
    v_max3_f32 v30, v30, v57, v58
    v_max3_f32 v30, v30, v59, v60
    v_max3_f32 v30, v30, v61, v62
    v_max3_f32 v30, v30, v63, v64
    v_max3_f32 v30, v30, v65, v66
    v_max_f32 v30, v30, v67
    v_cmp_lt_f32 vcc, s30, v30
    s_cbranch_vccnz as10_slow
as10_fast:
    v_exp_f32 v36, v36
    v_exp_f32 v37, v37
    v_exp_f32 v38, v38
    v_exp_f32 v39, v39
    v_exp_f32 v40, v40
    v_exp_f32 v41, v41
    v_exp_f32 v42, v42
    v_exp_f32 v43, v43
    v_exp_f32 v44, v44
    v_exp_f32 v45, v45
    v_exp_f32 v46, v46
    v_exp_f32 v47, v47
    v_exp_f32 v48, v48
    v_exp_f32 v49, v49
    v_exp_f32 v50, v50
    v_exp_f32 v51, v51
    v_cvt_pk_bf16_f32 v68, v36, v37
    v_cvt_pk_bf16_f32 v69, v38, v39
    v_cvt_pk_bf16_f32 v70, v40, v41
    v_cvt_pk_bf16_f32 v71, v42, v43
    s_waitcnt lgkmcnt(4)
    v_exp_f32 v52, v52
    v_exp_f32 v53, v53
    v_exp_f32 v54, v54
    v_exp_f32 v55, v55
    v_exp_f32 v56, v56
    v_exp_f32 v57, v57
    v_exp_f32 v58, v58
    v_exp_f32 v59, v59
    v_cvt_pk_bf16_f32 v72, v44, v45
    v_cvt_pk_bf16_f32 v73, v46, v47
    v_cvt_pk_bf16_f32 v74, v48, v49
    v_cvt_pk_bf16_f32 v75, v50, v51
    v_mfma_f32_32x32x16_bf16 v[84:99], v[148:151], v[68:71], v[84:99]
    v_mfma_f32_16x16x32_bf16 v[100:103], v[12:15], v[68:71], v[100:103]
    v_exp_f32 v60, v60
    v_exp_f32 v61, v61
    v_exp_f32 v62, v62
    v_exp_f32 v63, v63
    v_exp_f32 v64, v64
    v_exp_f32 v65, v65
    v_exp_f32 v66, v66
    v_exp_f32 v67, v67
    v_cvt_pk_bf16_f32 v76, v52, v53
    v_cvt_pk_bf16_f32 v77, v54, v55
    v_cvt_pk_bf16_f32 v78, v56, v57
    v_cvt_pk_bf16_f32 v79, v58, v59
    v_mfma_f32_32x32x16_bf16 v[84:99], v[152:155], v[72:75], v[84:99]
    v_mfma_f32_16x16x32_bf16 v[100:103], v[12:15], v[72:75], v[100:103]
    v_cvt_pk_bf16_f32 v80, v60, v61
    v_cvt_pk_bf16_f32 v81, v62, v63
    v_cvt_pk_bf16_f32 v82, v64, v65
    v_cvt_pk_bf16_f32 v83, v66, v67
    v_mfma_f32_32x32x16_bf16 v[84:99], v[156:159], v[76:79], v[84:99]
    v_mfma_f32_16x16x32_bf16 v[100:103], v[12:15], v[76:79], v[100:103]
    s_nop 1
    v_mfma_f32_32x32x16_bf16 v[84:99], v[160:163], v[80:83], v[84:99]
    v_mfma_f32_16x16x32_bf16 v[100:103], v[12:15], v[80:83], v[100:103]
    s_waitcnt lgkmcnt(2)
    v_mfma_f32_32x32x16_bf16 v[36:51], v[132:135], v[4:7], v[116:131]
    v_mfma_f32_32x32x16_bf16 v[36:51], v[136:139], v[8:11], v[36:51]
    s_waitcnt lgkmcnt(0)
    v_mfma_f32_32x32x16_bf16 v[52:67], v[140:143], v[4:7], v[116:131]
    v_mfma_f32_32x32x16_bf16 v[52:67], v[144:147], v[8:11], v[52:67]
    ds_read_b128 v[148:151], v22 offset:24576
    ds_read_b128 v[152:155], v23 offset:24576
    ds_read_b128 v[156:159], v24 offset:24576
    ds_read_b128 v[160:163], v25 offset:24576
    s_nop 5
    v_max3_f32 v30, v36, v37, v38
    v_max3_f32 v30, v30, v39, v40
    v_max3_f32 v30, v30, v41, v42
    v_max3_f32 v30, v30, v43, v44
    v_max3_f32 v30, v30, v45, v46
    v_max3_f32 v30, v30, v47, v48
    v_max3_f32 v30, v30, v49, v50
    v_max3_f32 v30, v30, v51, v52
    v_max3_f32 v30, v30, v53, v54
    v_max3_f32 v30, v30, v55, v56
    v_max3_f32 v30, v30, v57, v58
    v_max3_f32 v30, v30, v59, v60
    v_max3_f32 v30, v30, v61, v62
    v_max3_f32 v30, v30, v63, v64
    v_max3_f32 v30, v30, v65, v66
    v_max_f32 v30, v30, v67
    v_cmp_lt_f32 vcc, s30, v30
    s_cbranch_vccnz as11_slow
as11_fast:
    v_exp_f32 v36, v36
    v_exp_f32 v37, v37
    v_exp_f32 v38, v38
    v_exp_f32 v39, v39
    v_exp_f32 v40, v40
    v_exp_f32 v41, v41
    v_exp_f32 v42, v42
    v_exp_f32 v43, v43
    v_exp_f32 v44, v44
    v_exp_f32 v45, v45
    v_exp_f32 v46, v46
    v_exp_f32 v47, v47
    v_exp_f32 v48, v48
    v_exp_f32 v49, v49
    v_exp_f32 v50, v50
    v_exp_f32 v51, v51
    v_cvt_pk_bf16_f32 v68, v36, v37
    v_cvt_pk_bf16_f32 v69, v38, v39
    v_cvt_pk_bf16_f32 v70, v40, v41
    v_cvt_pk_bf16_f32 v71, v42, v43
    s_waitcnt lgkmcnt(0)
    v_exp_f32 v52, v52
    v_exp_f32 v53, v53
    v_exp_f32 v54, v54
    v_exp_f32 v55, v55
    v_exp_f32 v56, v56
    v_exp_f32 v57, v57
    v_exp_f32 v58, v58
    v_exp_f32 v59, v59
    v_cvt_pk_bf16_f32 v72, v44, v45
    v_cvt_pk_bf16_f32 v73, v46, v47
    v_cvt_pk_bf16_f32 v74, v48, v49
    v_cvt_pk_bf16_f32 v75, v50, v51
    v_mfma_f32_32x32x16_bf16 v[84:99], v[148:151], v[68:71], v[84:99]
    v_mfma_f32_16x16x32_bf16 v[100:103], v[12:15], v[68:71], v[100:103]
    v_exp_f32 v60, v60
    v_exp_f32 v61, v61
    v_exp_f32 v62, v62
    v_exp_f32 v63, v63
    v_exp_f32 v64, v64
    v_exp_f32 v65, v65
    v_exp_f32 v66, v66
    v_exp_f32 v67, v67
    v_cvt_pk_bf16_f32 v76, v52, v53
    v_cvt_pk_bf16_f32 v77, v54, v55
    v_cvt_pk_bf16_f32 v78, v56, v57
    v_cvt_pk_bf16_f32 v79, v58, v59
    v_mfma_f32_32x32x16_bf16 v[84:99], v[152:155], v[72:75], v[84:99]
    v_mfma_f32_16x16x32_bf16 v[100:103], v[12:15], v[72:75], v[100:103]
    v_cvt_pk_bf16_f32 v80, v60, v61
    v_cvt_pk_bf16_f32 v81, v62, v63
    v_cvt_pk_bf16_f32 v82, v64, v65
    v_cvt_pk_bf16_f32 v83, v66, v67
    v_mfma_f32_32x32x16_bf16 v[84:99], v[156:159], v[76:79], v[84:99]
    v_mfma_f32_16x16x32_bf16 v[100:103], v[12:15], v[76:79], v[100:103]
    s_nop 1
    v_mfma_f32_32x32x16_bf16 v[84:99], v[160:163], v[80:83], v[84:99]
    v_mfma_f32_16x16x32_bf16 v[100:103], v[12:15], v[80:83], v[100:103]
    s_cmp_lg_u32 s29, 0
    s_cbranch_scc1 as_loop
    s_nop 15
    s_nop 3
    s_branch at_epi
as00_slow:
    v_mov_b32 v31, v30
    s_nop 1
    v_permlane32_swap_b32 v30, v31
    s_nop 1
    v_max3_f32 v32, v30, v31, s31
    v_max_f32 v33, 0, v32
    v_exp_f32 v33, -v33
    v_sub_f32 v116, v116, v32
    v_sub_f32 v36, v36, v32
    v_sub_f32 v37, v37, v32
    v_sub_f32 v38, v38, v32
    v_sub_f32 v39, v39, v32
    v_sub_f32 v40, v40, v32
    v_sub_f32 v41, v41, v32
    v_sub_f32 v42, v42, v32
    v_sub_f32 v43, v43, v32
    v_sub_f32 v44, v44, v32
    v_sub_f32 v45, v45, v32
    v_sub_f32 v46, v46, v32
    v_sub_f32 v47, v47, v32
    v_sub_f32 v48, v48, v32
    v_sub_f32 v49, v49, v32
    v_sub_f32 v50, v50, v32
    v_sub_f32 v51, v51, v32
    v_sub_f32 v52, v52, v32
    v_sub_f32 v53, v53, v32
    v_sub_f32 v54, v54, v32
    v_sub_f32 v55, v55, v32
    v_sub_f32 v56, v56, v32
    v_sub_f32 v57, v57, v32
    v_sub_f32 v58, v58, v32
    v_sub_f32 v59, v59, v32
    v_sub_f32 v60, v60, v32
    v_sub_f32 v61, v61, v32
    v_sub_f32 v62, v62, v32
    v_sub_f32 v63, v63, v32
    v_sub_f32 v64, v64, v32
    v_sub_f32 v65, v65, v32
    v_sub_f32 v66, v66, v32
    v_sub_f32 v67, v67, v32
    v_mul_f32 v84, v84, v33
    v_mul_f32 v85, v85, v33
    v_mul_f32 v86, v86, v33
    v_mul_f32 v87, v87, v33
    v_mul_f32 v88, v88, v33
    v_mul_f32 v89, v89, v33
    v_mul_f32 v90, v90, v33
    v_mul_f32 v91, v91, v33
    v_mul_f32 v92, v92, v33
    v_mul_f32 v93, v93, v33
    v_mul_f32 v94, v94, v33
    v_mul_f32 v95, v95, v33
    v_mul_f32 v96, v96, v33
    v_mul_f32 v97, v97, v33
    v_mul_f32 v98, v98, v33
    v_mul_f32 v99, v99, v33
    v_mul_f32 v100, v100, v33
    v_mov_b32 v117, v116
    v_mov_b32 v118, v116
    v_mov_b32 v119, v116
    v_mov_b32 v120, v116
    v_mov_b32 v121, v116
    v_mov_b32 v122, v116
    v_mov_b32 v123, v116
    v_mov_b32 v124, v116
    v_mov_b32 v125, v116
    v_mov_b32 v126, v116
    v_mov_b32 v127, v116
    v_mov_b32 v128, v116
    v_mov_b32 v129, v116
    v_mov_b32 v130, v116
    v_mov_b32 v131, v116
    s_mov_b32 s30, 0x41000000
    s_mov_b32 s31, 0
    s_branch as00_fast
as01_slow:
    v_mov_b32 v31, v30
    s_nop 1
    v_permlane32_swap_b32 v30, v31
    s_nop 1
    v_max3_f32 v32, v30, v31, s31
    v_max_f32 v33, 0, v32
    v_exp_f32 v33, -v33
    v_sub_f32 v116, v116, v32
    v_sub_f32 v36, v36, v32
    v_sub_f32 v37, v37, v32
    v_sub_f32 v38, v38, v32
    v_sub_f32 v39, v39, v32
    v_sub_f32 v40, v40, v32
    v_sub_f32 v41, v41, v32
    v_sub_f32 v42, v42, v32
    v_sub_f32 v43, v43, v32
    v_sub_f32 v44, v44, v32
    v_sub_f32 v45, v45, v32
    v_sub_f32 v46, v46, v32
    v_sub_f32 v47, v47, v32
    v_sub_f32 v48, v48, v32
    v_sub_f32 v49, v49, v32
    v_sub_f32 v50, v50, v32
    v_sub_f32 v51, v51, v32
    v_sub_f32 v52, v52, v32
    v_sub_f32 v53, v53, v32
    v_sub_f32 v54, v54, v32
    v_sub_f32 v55, v55, v32
    v_sub_f32 v56, v56, v32
    v_sub_f32 v57, v57, v32
    v_sub_f32 v58, v58, v32
    v_sub_f32 v59, v59, v32
    v_sub_f32 v60, v60, v32
    v_sub_f32 v61, v61, v32
    v_sub_f32 v62, v62, v32
    v_sub_f32 v63, v63, v32
    v_sub_f32 v64, v64, v32
    v_sub_f32 v65, v65, v32
    v_sub_f32 v66, v66, v32
    v_sub_f32 v67, v67, v32
    v_mul_f32 v84, v84, v33
    v_mul_f32 v85, v85, v33
    v_mul_f32 v86, v86, v33
    v_mul_f32 v87, v87, v33
    v_mul_f32 v88, v88, v33
    v_mul_f32 v89, v89, v33
    v_mul_f32 v90, v90, v33
    v_mul_f32 v91, v91, v33
    v_mul_f32 v92, v92, v33
    v_mul_f32 v93, v93, v33
    v_mul_f32 v94, v94, v33
    v_mul_f32 v95, v95, v33
    v_mul_f32 v96, v96, v33
    v_mul_f32 v97, v97, v33
    v_mul_f32 v98, v98, v33
    v_mul_f32 v99, v99, v33
    v_mul_f32 v100, v100, v33
    v_mov_b32 v117, v116
    v_mov_b32 v118, v116
    v_mov_b32 v119, v116
    v_mov_b32 v120, v116
    v_mov_b32 v121, v116
    v_mov_b32 v122, v116
    v_mov_b32 v123, v116
    v_mov_b32 v124, v116
    v_mov_b32 v125, v116
    v_mov_b32 v126, v116
    v_mov_b32 v127, v116
    v_mov_b32 v128, v116
    v_mov_b32 v129, v116
    v_mov_b32 v130, v116
    v_mov_b32 v131, v116
    s_mov_b32 s30, 0x41000000
    s_mov_b32 s31, 0
    s_branch as01_fast
as10_slow:
    v_mov_b32 v31, v30
    s_nop 1
    v_permlane32_swap_b32 v30, v31
    s_nop 1
    v_max3_f32 v32, v30, v31, s31
    v_max_f32 v33, 0, v32
    v_exp_f32 v33, -v33
    v_sub_f32 v116, v116, v32
    v_sub_f32 v36, v36, v32
    v_sub_f32 v37, v37, v32
    v_sub_f32 v38, v38, v32
    v_sub_f32 v39, v39, v32
    v_sub_f32 v40, v40, v32
    v_sub_f32 v41, v41, v32
    v_sub_f32 v42, v42, v32
    v_sub_f32 v43, v43, v32
    v_sub_f32 v44, v44, v32
    v_sub_f32 v45, v45, v32
    v_sub_f32 v46, v46, v32
    v_sub_f32 v47, v47, v32
    v_sub_f32 v48, v48, v32
    v_sub_f32 v49, v49, v32
    v_sub_f32 v50, v50, v32
    v_sub_f32 v51, v51, v32
    v_sub_f32 v52, v52, v32
    v_sub_f32 v53, v53, v32
    v_sub_f32 v54, v54, v32
    v_sub_f32 v55, v55, v32
    v_sub_f32 v56, v56, v32
    v_sub_f32 v57, v57, v32
    v_sub_f32 v58, v58, v32
    v_sub_f32 v59, v59, v32
    v_sub_f32 v60, v60, v32
    v_sub_f32 v61, v61, v32
    v_sub_f32 v62, v62, v32
    v_sub_f32 v63, v63, v32
    v_sub_f32 v64, v64, v32
    v_sub_f32 v65, v65, v32
    v_sub_f32 v66, v66, v32
    v_sub_f32 v67, v67, v32
    v_mul_f32 v84, v84, v33
    v_mul_f32 v85, v85, v33
    v_mul_f32 v86, v86, v33
    v_mul_f32 v87, v87, v33
    v_mul_f32 v88, v88, v33
    v_mul_f32 v89, v89, v33
    v_mul_f32 v90, v90, v33
    v_mul_f32 v91, v91, v33
    v_mul_f32 v92, v92, v33
    v_mul_f32 v93, v93, v33
    v_mul_f32 v94, v94, v33
    v_mul_f32 v95, v95, v33
    v_mul_f32 v96, v96, v33
    v_mul_f32 v97, v97, v33
    v_mul_f32 v98, v98, v33
    v_mul_f32 v99, v99, v33
    v_mul_f32 v100, v100, v33
    v_mov_b32 v117, v116
    v_mov_b32 v118, v116
    v_mov_b32 v119, v116
    v_mov_b32 v120, v116
    v_mov_b32 v121, v116
    v_mov_b32 v122, v116
    v_mov_b32 v123, v116
    v_mov_b32 v124, v116
    v_mov_b32 v125, v116
    v_mov_b32 v126, v116
    v_mov_b32 v127, v116
    v_mov_b32 v128, v116
    v_mov_b32 v129, v116
    v_mov_b32 v130, v116
    v_mov_b32 v131, v116
    s_mov_b32 s30, 0x41000000
    s_mov_b32 s31, 0
    s_branch as10_fast
as11_slow:
    v_mov_b32 v31, v30
    s_nop 1
    v_permlane32_swap_b32 v30, v31
    s_nop 1
    v_max3_f32 v32, v30, v31, s31
    v_max_f32 v33, 0, v32
    v_exp_f32 v33, -v33
    v_sub_f32 v116, v116, v32
    v_sub_f32 v36, v36, v32
    v_sub_f32 v37, v37, v32
    v_sub_f32 v38, v38, v32
    v_sub_f32 v39, v39, v32
    v_sub_f32 v40, v40, v32
    v_sub_f32 v41, v41, v32
    v_sub_f32 v42, v42, v32
    v_sub_f32 v43, v43, v32
    v_sub_f32 v44, v44, v32
    v_sub_f32 v45, v45, v32
    v_sub_f32 v46, v46, v32
    v_sub_f32 v47, v47, v32
    v_sub_f32 v48, v48, v32
    v_sub_f32 v49, v49, v32
    v_sub_f32 v50, v50, v32
    v_sub_f32 v51, v51, v32
    v_sub_f32 v52, v52, v32
    v_sub_f32 v53, v53, v32
    v_sub_f32 v54, v54, v32
    v_sub_f32 v55, v55, v32
    v_sub_f32 v56, v56, v32
    v_sub_f32 v57, v57, v32
    v_sub_f32 v58, v58, v32
    v_sub_f32 v59, v59, v32
    v_sub_f32 v60, v60, v32
    v_sub_f32 v61, v61, v32
    v_sub_f32 v62, v62, v32
    v_sub_f32 v63, v63, v32
    v_sub_f32 v64, v64, v32
    v_sub_f32 v65, v65, v32
    v_sub_f32 v66, v66, v32
    v_sub_f32 v67, v67, v32
    v_mul_f32 v84, v84, v33
    v_mul_f32 v85, v85, v33
    v_mul_f32 v86, v86, v33
    v_mul_f32 v87, v87, v33
    v_mul_f32 v88, v88, v33
    v_mul_f32 v89, v89, v33
    v_mul_f32 v90, v90, v33
    v_mul_f32 v91, v91, v33
    v_mul_f32 v92, v92, v33
    v_mul_f32 v93, v93, v33
    v_mul_f32 v94, v94, v33
    v_mul_f32 v95, v95, v33
    v_mul_f32 v96, v96, v33
    v_mul_f32 v97, v97, v33
    v_mul_f32 v98, v98, v33
    v_mul_f32 v99, v99, v33
    v_mul_f32 v100, v100, v33
    v_mov_b32 v117, v116
    v_mov_b32 v118, v116
    v_mov_b32 v119, v116
    v_mov_b32 v120, v116
    v_mov_b32 v121, v116
    v_mov_b32 v122, v116
    v_mov_b32 v123, v116
    v_mov_b32 v124, v116
    v_mov_b32 v125, v116
    v_mov_b32 v126, v116
    v_mov_b32 v127, v116
    v_mov_b32 v128, v116
    v_mov_b32 v129, v116
    v_mov_b32 v130, v116
    v_mov_b32 v131, v116
    s_mov_b32 s30, 0x41000000
    s_mov_b32 s31, 0
    s_branch as11_fast
at_done:
    s_endpgm
.globl gemm4_kernel
.p2align 8
.type gemm4_kernel,@function
gemm4_kernel:
    s_cmp_ge_u32 s2, 256
    s_cbranch_scc1 g4_done
    s_load_dwordx16 s[48:63], s[0:1], 0
    s_load_dwordx2 s[64:65], s[0:1], 64
    s_and_b32 s30, s2, 7
    s_lshr_b32 s31, s2, 3
    s_lshl_b32 s30, s30, 5
    s_add_u32 s30, s30, s31
    s_lshr_b32 s23, s30, 3
    s_and_b32 s24, s30, 7
    v_lshrrev_b32 v1, 6, v0
    v_and_b32 v0, 63, v0
    s_nop 0
    v_readfirstlane_b32 s20, v1
    s_lshr_b32 s21, s20, 1
    s_and_b32 s22, s20, 1
    s_waitcnt lgkmcnt(0)
    s_add_u32 s4, s64, 16777216
    s_addc_u32 s5, s65, 0
    s_mov_b32 s6, 18874368
    s_mov_b32 s7, 0x00020000
    s_mov_b32 s8, s52
    s_mov_b32 s9, s53
    s_mov_b32 s10, 2097152
    s_mov_b32 s11, 0x00020000
    s_mov_b32 s12, s60
    s_mov_b32 s13, s61
    s_mov_b32 s14, 4194304
    s_mov_b32 s15, 0x00020000
    s_add_u32 s16, s64, 41943040
    s_addc_u32 s17, s65, 0
    s_mov_b32 s18, 16777216
    s_mov_b32 s19, 0x00020000
    s_mov_b32 s25, 9216
    s_mov_b32 s26, 2048
    s_mov_b32 s72, s48
    s_mov_b32 s73, s49
    s_mov_b32 s74, 4194304
    s_mov_b32 s75, 0x00020000
    v_lshlrev_b32 v16, 4, v0
    s_lshl_b32 s30, s23, 1
    s_add_u32 s30, s30, s21
    s_lshl_b32 s30, s30, 5
    s_lshl_b32 s31, s24, 2
    s_add_u32 s30, s30, s31
    s_lshl_b32 s31, s22, 1
    s_add_u32 s30, s30, s31
    s_lshl_b32 s30, s30, 12
    s_add_u32 s31, s30, 4096
    buffer_load_dwordx4 v[64:67], v16, s[16:19], s30 offen offset:0
    buffer_load_dwordx4 v[68:71], v16, s[16:19], s30 offen offset:1024
    buffer_load_dwordx4 v[72:75], v16, s[16:19], s30 offen offset:2048
    buffer_load_dwordx4 v[76:79], v16, s[16:19], s30 offen offset:3072
    buffer_load_dwordx4 v[80:83], v16, s[16:19], s31 offen offset:0
    buffer_load_dwordx4 v[84:87], v16, s[16:19], s31 offen offset:1024
    buffer_load_dwordx4 v[88:91], v16, s[16:19], s31 offen offset:2048
    buffer_load_dwordx4 v[92:95], v16, s[16:19], s31 offen offset:3072
    v_add_u32 v21, 0x800000, v16
    buffer_load_dwordx4 v[112:115], v21, s[16:19], s30 offen offset:0
    buffer_load_dwordx4 v[116:119], v21, s[16:19], s30 offen offset:1024
    buffer_load_dwordx4 v[120:123], v21, s[16:19], s30 offen offset:2048
    buffer_load_dwordx4 v[124:127], v21, s[16:19], s30 offen offset:3072
    buffer_load_dwordx4 v[128:131], v21, s[16:19], s31 offen offset:0
    buffer_load_dwordx4 v[132:135], v21, s[16:19], s31 offen offset:1024
    buffer_load_dwordx4 v[136:139], v21, s[16:19], s31 offen offset:2048
    buffer_load_dwordx4 v[140:143], v21, s[16:19], s31 offen offset:3072
    s_lshl_b32 s30, s23, 6
    s_lshl_b32 s31, s21, 5
    s_add_u32 s30, s30, s31
    v_lshrrev_b32 v17, 3, v0
    v_and_b32 v18, 7, v0
    v_add_u32 v19, s30, v17
    v_lshlrev_b32 v19, 11, v19
    v_lshl_add_u32 v19, v18, 4, v19
    s_lshl_b32 s30, s24, 8
    s_lshl_b32 s31, s22, 7
    s_add_u32 s35, s30, s31
    s_add_u32 s36, s35, 0
    buffer_load_dwordx4 v[96:99], v19, s[72:75], s36 offen
    s_add_u32 s36, s35, 16384
    buffer_load_dwordx4 v[100:103], v19, s[72:75], s36 offen
    s_add_u32 s36, s35, 32768
    buffer_load_dwordx4 v[104:107], v19, s[72:75], s36 offen
    s_add_u32 s36, s35, 49152
    buffer_load_dwordx4 v[108:111], v19, s[72:75], s36 offen
    v_lshrrev_b32 v16, 2, v0
    v_and_b32 v17, 3, v0
    v_lshrrev_b32 v18, 4, v0
    v_mul_lo_u32 v19, v16, s25
    v_xor_b32 v20, v17, v18
    v_lshl_add_u32 v2, v20, 4, v19
    s_lshl_b32 s30, s25, 4
    v_add_u32 v3, s30, v2
    v_lshrrev_b32 v18, 4, v0
    v_bfe_u32 v16, v0, 2, 2
    v_lshlrev_b32 v17, 4, v17
    v_mul_lo_u32 v19, v18, s26
    v_add_u32 v19, v19, v17
    s_mul_i32 s30, s26, 4
    v_or_b32 v20, 0, v18
    v_xor_b32 v20, v20, v16
    v_lshl_add_u32 v6, v20, 6, v19
    v_or_b32 v20, 0, v18
    v_xor_b32 v20, v20, v16
    v_lshl_add_u32 v7, v20, 6, v19
    v_add_u32 v7, s30, v7
    v_and_b32 v16, 31, v0
    v_lshrrev_b32 v17, 5, v0
    v_bfe_u32 v18, v0, 2, 2
    s_mul_i32 s30, s21, 2048
    v_lshlrev_b32 v19, 6, v16
    v_add_u32 v19, s30, v19
    v_or_b32 v20, 0, v17
    v_xor_b32 v20, v20, v18
    v_lshl_add_u32 v10, v20, 4, v19
    v_or_b32 v20, 2, v17
    v_xor_b32 v20, v20, v18
    v_lshl_add_u32 v11, v20, 4, v19
    v_bfe_u32 v16, v0, 2, 2
    v_lshrrev_b32 v17, 5, v0
    v_lshl_add_u32 v17, v17, 3, v16
    v_lshlrev_b32 v17, 8, v17
    v_bfe_u32 v18, v0, 4, 1
    v_lshl_add_u32 v17, v18, 5, v17
    v_and_b32 v18, 3, v0
    v_lshl_add_u32 v17, v18, 3, v17
    v_add_u32 v17, 4096, v17
    s_lshl_b32 s30, s22, 1
    s_add_u32 s31, s30, 0
    v_xor_b32 v18, s31, v16
    v_lshl_add_u32 v14, v18, 6, v17
    s_add_u32 s31, s30, 1
    v_xor_b32 v18, s31, v16
    v_lshl_add_u32 v15, v18, 6, v17
    s_mul_i32 s30, s23, 64
    s_mul_i32 s31, s20, 16
    s_add_u32 s30, s30, s31
    s_mul_i32 s27, s30, s25
    s_mul_i32 s30, s20, 8
    s_mul_i32 s28, s30, s26
    s_lshl_b32 s30, s24, 8
    s_add_u32 s28, s28, s30
    s_lshl_b32 s33, s26, 5
    s_mul_i32 s32, s20, 1024
    s_mul_i32 s34, s20, 2048
    s_add_u32 s34, s34, 4096
    s_mov_b32 s44, 0
    s_mov_b32 s45, 0x40000000
    s_cmp_lt_u32 s44, 32
    s_cselect_b32 s30, s27, s45
    s_cselect_b32 s31, s28, s45
    s_add_u32 m0, s32, 0
    s_nop 0
    buffer_load_dwordx4 v2, s[4:7], s30 offen lds
    s_add_u32 m0, s34, 0
    s_nop 0
    buffer_load_dwordx4 v6, s[8:11], s31 offen lds
    s_add_u32 m0, s34, 1024
    s_nop 0
    buffer_load_dwordx4 v7, s[8:11], s31 offen lds
    s_add_u32 s27, s27, 64
    s_add_u32 s28, s28, s33
    s_add_u32 s44, s44, 1
    s_cmp_lt_u32 s44, 32
    s_cselect_b32 s30, s27, s45
    s_cselect_b32 s31, s28, s45
    s_add_u32 m0, s32, 12288
    s_nop 0
    buffer_load_dwordx4 v2, s[4:7], s30 offen lds
    s_add_u32 m0, s34, 12288
    s_nop 0
    buffer_load_dwordx4 v6, s[8:11], s31 offen lds
    s_add_u32 m0, s34, 13312
    s_nop 0
    buffer_load_dwordx4 v7, s[8:11], s31 offen lds
    s_add_u32 s27, s27, 64
    s_add_u32 s28, s28, s33
    s_add_u32 s44, s44, 1
    s_cmp_lt_u32 s44, 32
    s_cselect_b32 s30, s27, s45
    s_cselect_b32 s31, s28, s45
    s_add_u32 m0, s32, 24576
    s_nop 0
    buffer_load_dwordx4 v2, s[4:7], s30 offen lds
    s_add_u32 m0, s34, 24576
    s_nop 0
    buffer_load_dwordx4 v6, s[8:11], s31 offen lds
    s_add_u32 m0, s34, 25600
    s_nop 0
    buffer_load_dwordx4 v7, s[8:11], s31 offen lds
    s_add_u32 s27, s27, 64
    s_add_u32 s28, s28, s33
    s_add_u32 s44, s44, 1
    s_cmp_lt_u32 s44, 32
    s_cselect_b32 s30, s27, s45
    s_cselect_b32 s31, s28, s45
    s_add_u32 m0, s32, 36864
    s_nop 0
    buffer_load_dwordx4 v2, s[4:7], s30 offen lds
    s_add_u32 m0, s34, 36864
    s_nop 0
    buffer_load_dwordx4 v6, s[8:11], s31 offen lds
    s_add_u32 m0, s34, 37888
    s_nop 0
    buffer_load_dwordx4 v7, s[8:11], s31 offen lds
    s_add_u32 s27, s27, 64
    s_add_u32 s28, s28, s33
    s_add_u32 s44, s44, 1
    s_cmp_lt_u32 s44, 32
    s_cselect_b32 s30, s27, s45
    s_cselect_b32 s31, s28, s45
    s_add_u32 m0, s32, 49152
    s_nop 0
    buffer_load_dwordx4 v2, s[4:7], s30 offen lds
    s_add_u32 m0, s34, 49152
    s_nop 0
    buffer_load_dwordx4 v6, s[8:11], s31 offen lds
    s_add_u32 m0, s34, 50176
    s_nop 0
    buffer_load_dwordx4 v7, s[8:11], s31 offen lds
    s_add_u32 s27, s27, 64
    s_add_u32 s28, s28, s33
    s_add_u32 s44, s44, 1
    s_cmp_lt_u32 s44, 32
    s_cselect_b32 s30, s27, s45
    s_cselect_b32 s31, s28, s45
    s_add_u32 m0, s32, 61440
    s_nop 0
    buffer_load_dwordx4 v2, s[4:7], s30 offen lds
    s_add_u32 m0, s34, 61440
    s_nop 0
    buffer_load_dwordx4 v6, s[8:11], s31 offen lds
    s_add_u32 m0, s34, 62464
    s_nop 0
    buffer_load_dwordx4 v7, s[8:11], s31 offen lds
    s_add_u32 s27, s27, 64
    s_add_u32 s28, s28, s33
    s_add_u32 s44, s44, 1
    s_waitcnt vmcnt(15)
    s_barrier
    ds_read_b128 v[32:35], v10 offset:0
    ds_read_b64_tr_b16 v[40:41], v14 offset:0
    ds_read_b64_tr_b16 v[42:43], v14 offset:1024
    ds_read_b64_tr_b16 v[44:45], v15 offset:0
    ds_read_b64_tr_b16 v[46:47], v15 offset:1024
    s_mov_b32 s29, 32
    s_mov_b32 s66, 0
    s_mov_b32 s67, 12288
    s_mov_b32 s46, 0
g4_loop:
    v_add_u32 v21, s66, v11
    v_add_u32 v22, s66, v14
    v_add_u32 v23, s66, v15
    s_waitcnt lgkmcnt(0)
    v_mfma_f32_32x32x16_bf16 v[64:79], v[40:43], v[32:35], v[64:79]
    ds_read_b128 v[48:51], v21 offset:0
    ds_read_b64_tr_b16 v[56:57], v22 offset:4096
    v_mfma_f32_32x32x16_bf16 v[80:95], v[44:47], v[32:35], v[80:95]
    ds_read_b64_tr_b16 v[58:59], v22 offset:5120
    ds_read_b64_tr_b16 v[60:61], v23 offset:4096
    ds_read_b64_tr_b16 v[62:63], v23 offset:5120
    v_add_u32 v24, s67, v10
    v_add_u32 v25, s67, v14
    v_add_u32 v26, s67, v15
    s_waitcnt vmcnt(12) lgkmcnt(0)
    s_barrier
    v_mfma_f32_32x32x16_bf16 v[64:79], v[56:59], v[48:51], v[64:79]
    ds_read_b128 v[32:35], v24 offset:0
    ds_read_b64_tr_b16 v[40:41], v25 offset:0
    s_cmp_lt_u32 s44, 32
    s_cselect_b32 s30, s27, s45
    s_cselect_b32 s31, s28, s45
    s_add_u32 s47, s32, s46
    s_add_u32 m0, s47, 0
    s_nop 0
    buffer_load_dwordx4 v2, s[4:7], s30 offen lds
    v_mfma_f32_32x32x16_bf16 v[80:95], v[60:63], v[48:51], v[80:95]
    ds_read_b64_tr_b16 v[42:43], v25 offset:1024
    ds_read_b64_tr_b16 v[44:45], v26 offset:0
    s_add_u32 s47, s34, s46
    s_add_u32 m0, s47, 0
    s_nop 0
    buffer_load_dwordx4 v6, s[8:11], s31 offen lds
    ds_read_b64_tr_b16 v[46:47], v26 offset:1024
    s_add_u32 s47, s34, s46
    s_add_u32 m0, s47, 1024
    s_nop 0
    buffer_load_dwordx4 v7, s[8:11], s31 offen lds
    s_add_u32 s27, s27, 64
    s_add_u32 s28, s28, s33
    s_add_u32 s44, s44, 1
    s_mov_b32 s46, s67
    s_mov_b32 s66, s67
    s_add_u32 s67, s67, 12288
    s_cmp_eq_u32 s67, 73728
    s_cselect_b32 s67, 0, s67
    s_sub_u32 s29, s29, 1
    s_cmp_lg_u32 s29, 0
    s_cbranch_scc1 g4_loop
    s_waitcnt vmcnt(0) lgkmcnt(0)
    s_nop 15
    s_nop 3
    s_lshl_b32 s30, s23, 6
    s_lshl_b32 s31, s21, 5
    s_add_u32 s30, s30, s31
    v_lshrrev_b32 v17, 3, v0
    v_and_b32 v18, 7, v0
    v_add_u32 v19, s30, v17
    v_lshlrev_b32 v19, 11, v19
    v_lshl_add_u32 v19, v18, 4, v19
    s_lshl_b32 s30, s24, 8
    s_lshl_b32 s31, s22, 7
    s_add_u32 s35, s30, s31
    s_barrier
    s_mul_i32 s41, s20, 8704
    v_and_b32 v20, 31, v0
    v_mul_u32_u24 v20, 272, v20
    v_lshrrev_b32 v21, 5, v0
    v_lshl_add_u32 v20, v21, 4, v20
    v_add_u32 v20, s41, v20
    v_add_f32 v64, v64, v112
    v_add_f32 v65, v65, v113
    v_add_f32 v66, v66, v114
    v_add_f32 v67, v67, v115
    ds_write_b128 v20, v[64:67] offset:0
    v_add_f32 v68, v68, v116
    v_add_f32 v69, v69, v117
    v_add_f32 v70, v70, v118
    v_add_f32 v71, v71, v119
    ds_write_b128 v20, v[68:71] offset:32
    v_add_f32 v72, v72, v120
    v_add_f32 v73, v73, v121
    v_add_f32 v74, v74, v122
    v_add_f32 v75, v75, v123
    ds_write_b128 v20, v[72:75] offset:64
    v_add_f32 v76, v76, v124
    v_add_f32 v77, v77, v125
    v_add_f32 v78, v78, v126
    v_add_f32 v79, v79, v127
    ds_write_b128 v20, v[76:79] offset:96
    v_add_f32 v80, v80, v128
    v_add_f32 v81, v81, v129
    v_add_f32 v82, v82, v130
    v_add_f32 v83, v83, v131
    ds_write_b128 v20, v[80:83] offset:128
    v_add_f32 v84, v84, v132
    v_add_f32 v85, v85, v133
    v_add_f32 v86, v86, v134
    v_add_f32 v87, v87, v135
    ds_write_b128 v20, v[84:87] offset:160
    v_add_f32 v88, v88, v136
    v_add_f32 v89, v89, v137
    v_add_f32 v90, v90, v138
    v_add_f32 v91, v91, v139
    ds_write_b128 v20, v[88:91] offset:192
    v_add_f32 v92, v92, v140
    v_add_f32 v93, v93, v141
    v_add_f32 v94, v94, v142
    v_add_f32 v95, v95, v143
    ds_write_b128 v20, v[92:95] offset:224
    v_mul_u32_u24 v20, 272, v17
    v_lshl_add_u32 v20, v18, 5, v20
    v_add_u32 v20, s41, v20
    s_waitcnt lgkmcnt(0)
    ds_read_b128 v[64:67], v20 offset:0
    ds_read_b128 v[68:71], v20 offset:16
    ds_read_b128 v[72:75], v20 offset:2176
    ds_read_b128 v[76:79], v20 offset:2192
    ds_read_b128 v[80:83], v20 offset:4352
    ds_read_b128 v[84:87], v20 offset:4368
    ds_read_b128 v[88:91], v20 offset:6528
    ds_read_b128 v[92:95], v20 offset:6544
    s_waitcnt vmcnt(0)
    s_waitcnt lgkmcnt(6)
    v_lshlrev_b32 v22, 16, v96
    v_and_b32 v23, 0xffff0000, v96
    v_add_f32 v64, v64, v22
    v_add_f32 v65, v65, v23
    v_cvt_pk_bf16_f32 v32, v64, v65
    v_lshlrev_b32 v22, 16, v97
    v_and_b32 v23, 0xffff0000, v97
    v_add_f32 v66, v66, v22
    v_add_f32 v67, v67, v23
    v_cvt_pk_bf16_f32 v33, v66, v67
    v_lshlrev_b32 v22, 16, v98
    v_and_b32 v23, 0xffff0000, v98
    v_add_f32 v68, v68, v22
    v_add_f32 v69, v69, v23
    v_cvt_pk_bf16_f32 v34, v68, v69
    v_lshlrev_b32 v22, 16, v99
    v_and_b32 v23, 0xffff0000, v99
    v_add_f32 v70, v70, v22
    v_add_f32 v71, v71, v23
    v_cvt_pk_bf16_f32 v35, v70, v71
    s_add_u32 s36, s35, 0
    buffer_store_dwordx4 v[32:35], v19, s[12:15], s36 offen
    s_waitcnt lgkmcnt(4)
    v_lshlrev_b32 v22, 16, v100
    v_and_b32 v23, 0xffff0000, v100
    v_add_f32 v72, v72, v22
    v_add_f32 v73, v73, v23
    v_cvt_pk_bf16_f32 v36, v72, v73
    v_lshlrev_b32 v22, 16, v101
    v_and_b32 v23, 0xffff0000, v101
    v_add_f32 v74, v74, v22
    v_add_f32 v75, v75, v23
    v_cvt_pk_bf16_f32 v37, v74, v75
    v_lshlrev_b32 v22, 16, v102
    v_and_b32 v23, 0xffff0000, v102
    v_add_f32 v76, v76, v22
    v_add_f32 v77, v77, v23
    v_cvt_pk_bf16_f32 v38, v76, v77
    v_lshlrev_b32 v22, 16, v103
    v_and_b32 v23, 0xffff0000, v103
    v_add_f32 v78, v78, v22
    v_add_f32 v79, v79, v23
    v_cvt_pk_bf16_f32 v39, v78, v79
    s_add_u32 s36, s35, 16384
    buffer_store_dwordx4 v[36:39], v19, s[12:15], s36 offen
    s_waitcnt lgkmcnt(2)
    v_lshlrev_b32 v22, 16, v104
    v_and_b32 v23, 0xffff0000, v104
    v_add_f32 v80, v80, v22
    v_add_f32 v81, v81, v23
    v_cvt_pk_bf16_f32 v40, v80, v81
    v_lshlrev_b32 v22, 16, v105
    v_and_b32 v23, 0xffff0000, v105
    v_add_f32 v82, v82, v22
    v_add_f32 v83, v83, v23
    v_cvt_pk_bf16_f32 v41, v82, v83
    v_lshlrev_b32 v22, 16, v106
    v_and_b32 v23, 0xffff0000, v106
    v_add_f32 v84, v84, v22
    v_add_f32 v85, v85, v23
    v_cvt_pk_bf16_f32 v42, v84, v85
    v_lshlrev_b32 v22, 16, v107
    v_and_b32 v23, 0xffff0000, v107
    v_add_f32 v86, v86, v22
    v_add_f32 v87, v87, v23
    v_cvt_pk_bf16_f32 v43, v86, v87
    s_add_u32 s36, s35, 32768
    buffer_store_dwordx4 v[40:43], v19, s[12:15], s36 offen
    s_waitcnt lgkmcnt(0)
    v_lshlrev_b32 v22, 16, v108
    v_and_b32 v23, 0xffff0000, v108
    v_add_f32 v88, v88, v22
    v_add_f32 v89, v89, v23
    v_cvt_pk_bf16_f32 v44, v88, v89
    v_lshlrev_b32 v22, 16, v109
    v_and_b32 v23, 0xffff0000, v109
    v_add_f32 v90, v90, v22
    v_add_f32 v91, v91, v23
    v_cvt_pk_bf16_f32 v45, v90, v91
    v_lshlrev_b32 v22, 16, v110
    v_and_b32 v23, 0xffff0000, v110
    v_add_f32 v92, v92, v22
    v_add_f32 v93, v93, v23
    v_cvt_pk_bf16_f32 v46, v92, v93
    v_lshlrev_b32 v22, 16, v111
    v_and_b32 v23, 0xffff0000, v111
    v_add_f32 v94, v94, v22
    v_add_f32 v95, v95, v23
    v_cvt_pk_bf16_f32 v47, v94, v95
    s_add_u32 s36, s35, 49152
    buffer_store_dwordx4 v[44:47], v19, s[12:15], s36 offen
g4_done:
    s_endpgm
.section .rodata,"a"
.p2align 6
.p2align 6
.amdhsa_kernel ln_kernel
  .amdhsa_next_free_vgpr 32
  .amdhsa_next_free_sgpr 102
  .amdhsa_accum_offset 32
  .amdhsa_group_segment_fixed_size 0
  .amdhsa_kernarg_size 72
  .amdhsa_user_sgpr_count 2
  .amdhsa_user_sgpr_kernarg_segment_ptr 1
  .amdhsa_system_sgpr_workgroup_id_x 1
.end_amdhsa_kernel
.p2align 6
.amdhsa_kernel gemm1_kernel
  .amdhsa_next_free_vgpr 208
  .amdhsa_next_free_sgpr 102
  .amdhsa_accum_offset 208
  .amdhsa_group_segment_fixed_size 0
  .amdhsa_kernarg_size 72
  .amdhsa_user_sgpr_count 2
  .amdhsa_user_sgpr_kernarg_segment_ptr 1
  .amdhsa_system_sgpr_workgroup_id_x 1
.end_amdhsa_kernel
.p2align 6
.amdhsa_kernel attn_kernel
  .amdhsa_next_free_vgpr 168
  .amdhsa_next_free_sgpr 102
  .amdhsa_accum_offset 168
  .amdhsa_group_segment_fixed_size 0
  .amdhsa_kernarg_size 72
  .amdhsa_user_sgpr_count 2
  .amdhsa_user_sgpr_kernarg_segment_ptr 1
  .amdhsa_system_sgpr_workgroup_id_x 1
.end_amdhsa_kernel
.p2align 6
.amdhsa_kernel gemm4_kernel
  .amdhsa_next_free_vgpr 144
  .amdhsa_next_free_sgpr 102
  .amdhsa_accum_offset 144
  .amdhsa_group_segment_fixed_size 0
  .amdhsa_kernarg_size 72
  .amdhsa_user_sgpr_count 2
  .amdhsa_user_sgpr_kernarg_segment_ptr 1
  .amdhsa_system_sgpr_workgroup_id_x 1
.end_amdhsa_kernel
```
